```python
import torch

def _softmax(x, axis=-1):
    return torch.softmax(x, dim=axis)
def _gelu(x):
    return torch.nn.functional.gelu(x, approximate="tanh")
def _silu(x):
    return torch.nn.functional.silu(x)
def _sigmoid(x):
    return torch.sigmoid(x)
def _layernorm(x, axis=-1, eps=1e-5):
    m = x.mean(dim=axis, keepdim=True)
    v = x.var(dim=axis, keepdim=True, unbiased=False)
    return (x - m) / torch.sqrt(v + eps)
def _scatter_add(tgt, idx, src, axis=0):
    return tgt.clone().index_add_(axis, idx, src)
def _segment_sum(src, seg, n):
    out = torch.zeros((n,) + src.shape[1:], dtype=src.dtype)
    return out.index_add_(0, seg, src)
def _pad(x, pw):
    flat = tuple(v for pair in reversed(pw) for v in pair)
    return torch.nn.functional.pad(x, flat)

kernel_name = 'standalone__kv_cache_quant_int4_int2_kv_with_per_channel_or_per_token_scales__prompt'

def setup_inputs():

    _w = (lambda a: (lambda t: t.to(torch.bfloat16) if t.is_floating_point() else t)(torch.as_tensor(a)))
    B = 1
    Sq = 2048
    Skv = 2048
    Hq = 32
    Hkv = 32
    Dh = 128
    bits = 3
    G = 128
    if G <= 0 or G >= Skv:
        G = max(1, Skv // 2)
    Skv = (Skv // G) * G
    ngk = Skv // G
    qmax = (1 << bits) - 1
    return {
        "q": _w((lambda *s: torch.randn(*s, dtype=torch.bfloat16) * 1.6)(B, Hq, Sq, Dh)),
        "qk": _w(torch.randint(0, qmax + 1, (B, Hkv, Skv, Dh)).to(torch.int32)),
        "qv": _w(torch.randint(0, qmax + 1, (B, Hkv, Skv, Dh)).to(torch.int32)),
        "k_scales": _w(torch.abs((lambda *s: torch.randn(*s, dtype=torch.bfloat16) * 1.6)(B, Hkv, ngk, Dh)) * 0.05 + 0.02),
        "k_zeros": _w((lambda *s: torch.randn(*s, dtype=torch.bfloat16) * 1.6)(B, Hkv, ngk, Dh) + float(qmax) / 2.0),
        "v_scales": _w(torch.abs((lambda *s: torch.randn(*s, dtype=torch.bfloat16) * 0.05)(B, Hkv, Skv, 1)) * 0.05 + 0.02),
        "v_zeros": _w((lambda *s: torch.randn(*s, dtype=torch.bfloat16) * 0.05)(B, Hkv, Skv, 1) + float(qmax) / 2.0),
    }

def reference(q, qk, qv, k_scales, k_zeros, v_scales, v_zeros):
    B, Hq, Sq, Dh = q.shape
    Hkv, Skv = qk.shape[1], qk.shape[2]
    ngk = k_scales.shape[2]
    G = Skv // ngk
    ks = (lambda x, n, axis: torch.repeat_interleave(x, n, dim=axis))(k_scales, G, axis=2)
    kz = (lambda x, n, axis: torch.repeat_interleave(x, n, dim=axis))(k_zeros, G, axis=2)
    k = ((lambda x, dt: x.to(dt))(qk, q.dtype) - kz) * ks
    v = ((lambda x, dt: x.to(dt))(qv, q.dtype) - v_zeros) * v_scales
    rep = Hq // Hkv
    if rep > 1:
        k = (lambda x, n, axis: torch.repeat_interleave(x, n, dim=axis))(k, rep, axis=1)
        v = (lambda x, n, axis: torch.repeat_interleave(x, n, dim=axis))(v, rep, axis=1)
    scale = float(Dh) ** -0.5
    logits = torch.einsum("bhqd,bhkd->bhqk", q, k) * scale
    p = _softmax(logits, axis=-1)
    o = torch.einsum("bhqk,bhkd->bhqd", p, v)
    return o
```

```asm
; @launch grid=(256,1,1) block=(256,1,1) lds=149760
.amdgcn_target "amdgcn-amd-amdhsa--gfx950"
.text
.globl standalone__kv_cache_quant_int4_int2_kv_with_per_channel_or_per_token_scales__prompt_kernel
.p2align 8
.type standalone__kv_cache_quant_int4_int2_kv_with_per_channel_or_per_token_scales__prompt_kernel,@function
standalone__kv_cache_quant_int4_int2_kv_with_per_channel_or_per_token_scales__prompt_kernel:
    s_cmp_ge_u32 s2, 0x100
    s_cbranch_scc1 L_done
    s_load_dwordx16 s[64:79], s[0:1], 0
    s_load_dwordx4 s[80:83], s[0:1], 64
    v_and_b32 v175, 63, v0
    v_lshrrev_b32 v167, 6, v0
    v_mov_b32 v166, v0
    v_readfirstlane_b32 s28, v167
    s_and_b32 s38, s2, 7
    s_lshl_b32 s38, s38, 2
    s_lshr_b32 s84, s2, 6
    s_add_u32 s38, s38, s84
    s_lshr_b32 s39, s2, 3
    s_and_b32 s39, s39, 7
    s_mov_b32 s55, 0
    s_and_b32 s53, s39, 1
    s_lshr_b32 s54, s39, 1
    s_lshl_b32 s84, s38, 19
    s_lshl_b32 s85, s39, 16
    s_add_u32 s84, s84, s85
    s_lshl_b32 s86, s38, 20
    s_lshl_b32 s29, s28, 14
    s_add_u32 s87, s86, s29
    s_lshl_b32 s88, s38, 12
    s_mul_i32 s89, s38, 0x1100
    s_add_u32 s89, s89, 0x3000000
    v_and_b32 v164, 15, v175
    v_lshrrev_b32 v165, 4, v175
    v_lshlrev_b32 v176, 4, v175
    s_lshr_b32 s90, s28, 1
    s_and_b32 s91, s28, 1
    s_lshl_b32 s92, s53, 1
    s_add_u32 s92, s92, s91
    s_lshl_b32 s93, s54, 1
    s_add_u32 s93, s93, s90
    s_lshl_b32 s93, s93, 13
    s_lshl_b32 s94, s92, 7
    s_add_u32 s93, s93, s94
    v_lshlrev_b32 v226, 9, v164
    v_lshl_add_u32 v226, v165, 5, v226
    v_add_u32 v226, s93, v226
    s_lshl_b32 s95, s53, 2
    s_add_u32 s95, s95, s28
    s_lshl_b32 s93, s54, 14
    s_lshl_b32 s94, s95, 6
    s_add_u32 s93, s93, s94
    v_lshrrev_b32 v167, 1, v175
    v_and_b32 v168, 1, v175
    v_lshlrev_b32 v229, 3, v167
    v_lshlrev_b32 v167, 9, v167
    v_lshl_add_u32 v167, v168, 5, v167
    v_add_u32 v227, s93, v167
    v_add_u32 v229, 0x22000, v229
    v_lshrrev_b32 v167, 4, v166
    v_and_b32 v168, 15, v166
    s_lshl_b32 s93, s53, 7
    v_lshlrev_b32 v160, 8, v167
    v_lshl_add_u32 v160, v168, 3, v160
    v_add_u32 v160, s93, v160
    s_lshl_b32 s93, s54, 6
    v_lshlrev_b32 v161, 8, v167
    v_lshl_add_u32 v161, v168, 2, v161
    v_add_u32 v161, s93, v161
    v_lshlrev_b32 v162, 9, v167
    v_lshl_add_u32 v162, v168, 4, v162
    v_add_u32 v162, 0x20000, v162
    v_lshlrev_b32 v163, 4, v166
    v_add_u32 v163, 0x22000, v163
    s_waitcnt lgkmcnt(0)
    s_add_u32 s4, s66, s86
    s_addc_u32 s5, s67, 0
    s_mov_b32 s12, s4
    s_and_b32 s13, s5, 0xffff
    s_mov_b32 s14, 0x100000
    s_mov_b32 s15, 0x20000
    s_add_u32 s4, s68, s86
    s_addc_u32 s5, s69, 0
    s_mov_b32 s16, s4
    s_and_b32 s17, s5, 0xffff
    s_mov_b32 s18, 0x100000
    s_mov_b32 s19, 0x20000
    s_mov_b32 s31, 0
    buffer_load_dwordx4 v[0:3], v226, s[12:15], s31 offen
    buffer_load_dwordx4 v[4:7], v226, s[12:15], s31 offen offset:16
    buffer_load_dwordx4 v[8:11], v227, s[16:19], s31 offen
    buffer_load_dwordx4 v[12:15], v227, s[16:19], s31 offen offset:16
    s_add_u32 s70, s70, s88
    s_addc_u32 s71, s71, 0
    s_add_u32 s72, s72, s88
    s_addc_u32 s73, s73, 0
    s_add_u32 s74, s74, s88
    s_addc_u32 s75, s75, 0
    s_add_u32 s76, s76, s88
    s_addc_u32 s77, s77, 0
    global_load_dwordx2 v[240:241], v160, s[70:71]
    global_load_dwordx2 v[242:243], v160, s[72:73]
    global_load_dword v244, v161, s[74:75]
    global_load_dword v245, v161, s[76:77]
    s_add_u32 s4, s82, s89
    s_addc_u32 s5, s83, 0
    s_mov_b32 s60, s4
    s_and_b32 s61, s5, 0xffff
    s_mov_b32 s62, 0x100
    s_mov_b32 s63, 0x20000
    v_lshlrev_b32 v237, 12, v175
    v_add_u32 v236, 0x80, v237
    buffer_load_dword v234, v236, s[60:63], 0 offen
    s_add_u32 s31, s31, 0x10000
    buffer_load_dwordx4 v[16:19], v226, s[12:15], s31 offen
    buffer_load_dwordx4 v[20:23], v226, s[12:15], s31 offen offset:16
    buffer_load_dwordx4 v[24:27], v227, s[16:19], s31 offen
    buffer_load_dwordx4 v[28:31], v227, s[16:19], s31 offen offset:16
    s_add_u32 s4, s64, s84
    s_addc_u32 s5, s65, 0
    s_mov_b32 s8, s4
    s_and_b32 s9, s5, 0xffff
    s_mov_b32 s10, 0x10000
    s_mov_b32 s11, 0x20000
    v_lshlrev_b32 v180, 8, v164
    v_lshl_add_u32 v180, v165, 4, v180
    s_lshl_b32 s58, s28, 14
    s_add_u32 s56, s78, s84
    s_addc_u32 s57, s79, 0
    s_add_u32 s4, s82, s86
    s_addc_u32 s5, s83, 0
    s_mov_b32 s20, s4
    s_and_b32 s21, s5, 0xffff
    s_mov_b32 s22, 0x100000
    s_mov_b32 s23, 0x20000
    s_add_u32 s24, s82, s87
    s_addc_u32 s25, s83, 0
    s_lshl_b32 s93, s28, 12
    s_add_u32 s94, s86, s93
    s_add_u32 s6, s82, s94
    s_addc_u32 s7, s83, 0
    s_mov_b32 s59, s93
    v_add_u32 v177, 0x1000, v176
    v_add_u32 v178, 0x2000, v176
    v_add_u32 v179, 0x3000, v176
    s_lshl_b32 s93, s90, 2
    s_add_u32 s93, s93, s92
    s_lshl_b32 s93, s93, 10
    s_lshl_b32 s94, s54, 14
    s_add_u32 s93, s93, s94
    v_add_u32 v232, s93, v176
    s_lshl_b32 s93, s91, 7
    s_add_u32 s93, s93, 0x20000
    v_lshlrev_b32 v228, 5, v165
    v_add_u32 v228, s93, v228
    s_lshl_b32 s93, s54, 14
    s_lshl_b32 s94, s95, 10
    s_add_u32 s93, s93, s94
    s_add_u32 s93, s93, 0x2000
    v_add_u32 v233, s93, v176
    v_lshrrev_b32 v167, 2, v164
    v_lshl_add_u32 v167, v165, 2, v167
    v_lshlrev_b32 v167, 5, v167
    v_and_b32 v168, 3, v164
    v_lshl_add_u32 v167, v168, 3, v167
    s_lshl_b32 s93, s28, 10
    s_add_u32 s93, s93, 0x23000
    v_add_u32 v230, s93, v176
    v_add_u32 v231, s93, v167
    s_lshl_b32 s93, s28, 3
    v_add_u32 v237, s93, v237
    s_lshl_b32 s93, s39, 2
    v_lshlrev_b32 v238, 12, v166
    v_add_u32 v238, s93, v238
    s_mov_b32 s93, 0x3e0293ee
    s_waitcnt vmcnt(8)
    v_lshlrev_b32 v196, 16, v240
    v_and_b32 v197, 0xffff0000, v240
    v_lshlrev_b32 v198, 16, v241
    v_and_b32 v199, 0xffff0000, v241
    s_waitcnt vmcnt(7)
    v_lshlrev_b32 v200, 16, v242
    v_and_b32 v201, 0xffff0000, v242
    v_lshlrev_b32 v202, 16, v243
    v_and_b32 v203, 0xffff0000, v243
    v_mul_f32 v196, s93, v196
    v_mul_f32 v197, s93, v197
    v_mul_f32 v198, s93, v198
    v_mul_f32 v199, s93, v199
    v_mul_f32 v200, v200, v196
    v_mul_f32 v201, v201, v197
    v_mul_f32 v202, v202, v198
    v_mul_f32 v203, v203, v199
    v_xor_b32 v200, 0x80000000, v200
    v_xor_b32 v201, 0x80000000, v201
    v_xor_b32 v202, 0x80000000, v202
    v_xor_b32 v203, 0x80000000, v203
    ds_write_b128 v162, v[196:199]
    ds_write_b128 v162, v[200:203] offset:256
    s_waitcnt vmcnt(6)
    v_lshlrev_b32 v204, 16, v244
    v_and_b32 v206, 0xffff0000, v244
    s_waitcnt vmcnt(5)
    v_lshlrev_b32 v205, 16, v245
    v_and_b32 v207, 0xffff0000, v245
    v_mul_f32 v205, v205, v204
    v_mul_f32 v207, v207, v206
    v_xor_b32 v205, 0x80000000, v205
    v_xor_b32 v207, 0x80000000, v207
    ds_write_b128 v163, v[204:207]
    s_waitcnt lgkmcnt(0)
    s_barrier
    s_mov_b32 s32, 0
    s_mov_b32 s32, 0
    ds_read_b128 v[196:199], v228
    ds_read_b128 v[204:207], v228 offset:256
    ds_read_b128 v[200:203], v228 offset:16
    ds_read_b128 v[208:211], v228 offset:272
    ds_read_b64 v[212:213], v229
    v_cvt_f32_i32 v240, v0
    v_cvt_f32_i32 v241, v1
    v_cvt_f32_i32 v242, v2
    v_cvt_f32_i32 v243, v3
    v_cvt_f32_i32 v244, v4
    v_cvt_f32_i32 v245, v5
    v_cvt_f32_i32 v246, v6
    v_cvt_f32_i32 v247, v7
    v_cvt_f32_i32 v248, v8
    v_cvt_f32_i32 v249, v9
    v_cvt_f32_i32 v250, v10
    v_cvt_f32_i32 v251, v11
    v_cvt_f32_i32 v252, v12
    v_cvt_f32_i32 v253, v13
    v_cvt_f32_i32 v254, v14
    v_cvt_f32_i32 v255, v15
    s_mov_b32 s31, 0x20000
    buffer_load_dwordx4 v[32:35], v226, s[12:15], s31 offen
    buffer_load_dwordx4 v[36:39], v226, s[12:15], s31 offen offset:16
    buffer_load_dwordx4 v[40:43], v227, s[16:19], s31 offen
    buffer_load_dwordx4 v[44:47], v227, s[16:19], s31 offen offset:16
    s_waitcnt lgkmcnt(3)
    v_fma_f32 v240, v240, v196, v204
    v_fma_f32 v241, v241, v197, v205
    v_fma_f32 v242, v242, v198, v206
    v_fma_f32 v243, v243, v199, v207
    s_waitcnt lgkmcnt(1)
    v_fma_f32 v244, v244, v200, v208
    v_fma_f32 v245, v245, v201, v209
    v_fma_f32 v246, v246, v202, v210
    v_fma_f32 v247, v247, v203, v211
    v_cvt_pk_bf16_f32 v214, v240, v241
    v_cvt_pk_bf16_f32 v215, v242, v243
    v_cvt_pk_bf16_f32 v216, v244, v245
    v_cvt_pk_bf16_f32 v217, v246, v247
    s_waitcnt lgkmcnt(0)
    v_fma_f32 v248, v248, v212, v213
    v_fma_f32 v249, v249, v212, v213
    v_fma_f32 v250, v250, v212, v213
    v_fma_f32 v251, v251, v212, v213
    v_fma_f32 v252, v252, v212, v213
    v_fma_f32 v253, v253, v212, v213
    v_fma_f32 v254, v254, v212, v213
    v_fma_f32 v255, v255, v212, v213
    v_cvt_pk_bf16_f32 v218, v248, v249
    v_cvt_pk_bf16_f32 v219, v250, v251
    v_cvt_pk_bf16_f32 v220, v252, v253
    v_cvt_pk_bf16_f32 v221, v254, v255
    ds_write_b128 v230, v[218:221]
    ds_read_b64_tr_b16 v[222:223], v231
    ds_read_b64_tr_b16 v[224:225], v231 offset:512
    buffer_store_dwordx4 v[214:217], v232, s[20:23], s32 offen sc1
    s_waitcnt lgkmcnt(0)
    buffer_store_dwordx4 v[222:225], v233, s[20:23], s32 offen sc1
    s_mov_b32 s32, 0x10000
    ds_read_b128 v[196:199], v228 offset:512
    ds_read_b128 v[204:207], v228 offset:768
    ds_read_b128 v[200:203], v228 offset:528
    ds_read_b128 v[208:211], v228 offset:784
    ds_read_b64 v[212:213], v229 offset:256
    s_waitcnt vmcnt(9)
    v_cvt_f32_i32 v240, v16
    v_cvt_f32_i32 v241, v17
    v_cvt_f32_i32 v242, v18
    v_cvt_f32_i32 v243, v19
    s_waitcnt vmcnt(8)
    v_cvt_f32_i32 v244, v20
    v_cvt_f32_i32 v245, v21
    v_cvt_f32_i32 v246, v22
    v_cvt_f32_i32 v247, v23
    s_waitcnt vmcnt(7)
    v_cvt_f32_i32 v248, v24
    v_cvt_f32_i32 v249, v25
    v_cvt_f32_i32 v250, v26
    v_cvt_f32_i32 v251, v27
    s_waitcnt vmcnt(6)
    v_cvt_f32_i32 v252, v28
    v_cvt_f32_i32 v253, v29
    v_cvt_f32_i32 v254, v30
    v_cvt_f32_i32 v255, v31
    s_mov_b32 s31, 0x30000
    buffer_load_dwordx4 v[48:51], v226, s[12:15], s31 offen
    buffer_load_dwordx4 v[52:55], v226, s[12:15], s31 offen offset:16
    buffer_load_dwordx4 v[56:59], v227, s[16:19], s31 offen
    buffer_load_dwordx4 v[60:63], v227, s[16:19], s31 offen offset:16
    s_waitcnt lgkmcnt(3)
    v_fma_f32 v240, v240, v196, v204
    v_fma_f32 v241, v241, v197, v205
    v_fma_f32 v242, v242, v198, v206
    v_fma_f32 v243, v243, v199, v207
    s_waitcnt lgkmcnt(1)
    v_fma_f32 v244, v244, v200, v208
    v_fma_f32 v245, v245, v201, v209
    v_fma_f32 v246, v246, v202, v210
    v_fma_f32 v247, v247, v203, v211
    v_cvt_pk_bf16_f32 v214, v240, v241
    v_cvt_pk_bf16_f32 v215, v242, v243
    v_cvt_pk_bf16_f32 v216, v244, v245
    v_cvt_pk_bf16_f32 v217, v246, v247
    s_waitcnt lgkmcnt(0)
    v_fma_f32 v248, v248, v212, v213
    v_fma_f32 v249, v249, v212, v213
    v_fma_f32 v250, v250, v212, v213
    v_fma_f32 v251, v251, v212, v213
    v_fma_f32 v252, v252, v212, v213
    v_fma_f32 v253, v253, v212, v213
    v_fma_f32 v254, v254, v212, v213
    v_fma_f32 v255, v255, v212, v213
    v_cvt_pk_bf16_f32 v218, v248, v249
    v_cvt_pk_bf16_f32 v219, v250, v251
    v_cvt_pk_bf16_f32 v220, v252, v253
    v_cvt_pk_bf16_f32 v221, v254, v255
    ds_write_b128 v230, v[218:221]
    ds_read_b64_tr_b16 v[222:223], v231
    ds_read_b64_tr_b16 v[224:225], v231 offset:512
    buffer_store_dwordx4 v[214:217], v232, s[20:23], s32 offen sc1
    s_waitcnt lgkmcnt(0)
    buffer_store_dwordx4 v[222:225], v233, s[20:23], s32 offen sc1
    s_mov_b32 s32, 0x20000
    ds_read_b128 v[196:199], v228 offset:1024
    ds_read_b128 v[204:207], v228 offset:1280
    ds_read_b128 v[200:203], v228 offset:1040
    ds_read_b128 v[208:211], v228 offset:1296
    ds_read_b64 v[212:213], v229 offset:512
    s_waitcnt vmcnt(11)
    v_cvt_f32_i32 v240, v32
    v_cvt_f32_i32 v241, v33
    v_cvt_f32_i32 v242, v34
    v_cvt_f32_i32 v243, v35
    s_waitcnt vmcnt(10)
    v_cvt_f32_i32 v244, v36
    v_cvt_f32_i32 v245, v37
    v_cvt_f32_i32 v246, v38
    v_cvt_f32_i32 v247, v39
    s_waitcnt vmcnt(9)
    v_cvt_f32_i32 v248, v40
    v_cvt_f32_i32 v249, v41
    v_cvt_f32_i32 v250, v42
    v_cvt_f32_i32 v251, v43
    s_waitcnt vmcnt(8)
    v_cvt_f32_i32 v252, v44
    v_cvt_f32_i32 v253, v45
    v_cvt_f32_i32 v254, v46
    v_cvt_f32_i32 v255, v47
    s_waitcnt lgkmcnt(3)
    v_fma_f32 v240, v240, v196, v204
    v_fma_f32 v241, v241, v197, v205
    v_fma_f32 v242, v242, v198, v206
    v_fma_f32 v243, v243, v199, v207
    s_waitcnt lgkmcnt(1)
    v_fma_f32 v244, v244, v200, v208
    v_fma_f32 v245, v245, v201, v209
    v_fma_f32 v246, v246, v202, v210
    v_fma_f32 v247, v247, v203, v211
    v_cvt_pk_bf16_f32 v214, v240, v241
    v_cvt_pk_bf16_f32 v215, v242, v243
    v_cvt_pk_bf16_f32 v216, v244, v245
    v_cvt_pk_bf16_f32 v217, v246, v247
    s_waitcnt lgkmcnt(0)
    v_fma_f32 v248, v248, v212, v213
    v_fma_f32 v249, v249, v212, v213
    v_fma_f32 v250, v250, v212, v213
    v_fma_f32 v251, v251, v212, v213
    v_fma_f32 v252, v252, v212, v213
    v_fma_f32 v253, v253, v212, v213
    v_fma_f32 v254, v254, v212, v213
    v_fma_f32 v255, v255, v212, v213
    v_cvt_pk_bf16_f32 v218, v248, v249
    v_cvt_pk_bf16_f32 v219, v250, v251
    v_cvt_pk_bf16_f32 v220, v252, v253
    v_cvt_pk_bf16_f32 v221, v254, v255
    ds_write_b128 v230, v[218:221]
    ds_read_b64_tr_b16 v[222:223], v231
    ds_read_b64_tr_b16 v[224:225], v231 offset:512
    buffer_store_dwordx4 v[214:217], v232, s[20:23], s32 offen sc1
    s_waitcnt lgkmcnt(0)
    buffer_store_dwordx4 v[222:225], v233, s[20:23], s32 offen sc1
    s_mov_b32 s32, 0x30000
    ds_read_b128 v[196:199], v228 offset:1536
    ds_read_b128 v[204:207], v228 offset:1792
    ds_read_b128 v[200:203], v228 offset:1552
    ds_read_b128 v[208:211], v228 offset:1808
    ds_read_b64 v[212:213], v229 offset:768
    s_waitcnt vmcnt(7)
    v_cvt_f32_i32 v240, v48
    v_cvt_f32_i32 v241, v49
    v_cvt_f32_i32 v242, v50
    v_cvt_f32_i32 v243, v51
    s_waitcnt vmcnt(6)
    v_cvt_f32_i32 v244, v52
    v_cvt_f32_i32 v245, v53
    v_cvt_f32_i32 v246, v54
    v_cvt_f32_i32 v247, v55
    s_waitcnt vmcnt(5)
    v_cvt_f32_i32 v248, v56
    v_cvt_f32_i32 v249, v57
    v_cvt_f32_i32 v250, v58
    v_cvt_f32_i32 v251, v59
    s_waitcnt vmcnt(4)
    v_cvt_f32_i32 v252, v60
    v_cvt_f32_i32 v253, v61
    v_cvt_f32_i32 v254, v62
    v_cvt_f32_i32 v255, v63
    s_waitcnt lgkmcnt(3)
    v_fma_f32 v240, v240, v196, v204
    v_fma_f32 v241, v241, v197, v205
    v_fma_f32 v242, v242, v198, v206
    v_fma_f32 v243, v243, v199, v207
    s_waitcnt lgkmcnt(1)
    v_fma_f32 v244, v244, v200, v208
    v_fma_f32 v245, v245, v201, v209
    v_fma_f32 v246, v246, v202, v210
    v_fma_f32 v247, v247, v203, v211
    v_cvt_pk_bf16_f32 v214, v240, v241
    v_cvt_pk_bf16_f32 v215, v242, v243
    v_cvt_pk_bf16_f32 v216, v244, v245
    v_cvt_pk_bf16_f32 v217, v246, v247
    s_waitcnt lgkmcnt(0)
    v_fma_f32 v248, v248, v212, v213
    v_fma_f32 v249, v249, v212, v213
    v_fma_f32 v250, v250, v212, v213
    v_fma_f32 v251, v251, v212, v213
    v_fma_f32 v252, v252, v212, v213
    v_fma_f32 v253, v253, v212, v213
    v_fma_f32 v254, v254, v212, v213
    v_fma_f32 v255, v255, v212, v213
    v_cvt_pk_bf16_f32 v218, v248, v249
    v_cvt_pk_bf16_f32 v219, v250, v251
    v_cvt_pk_bf16_f32 v220, v252, v253
    v_cvt_pk_bf16_f32 v221, v254, v255
    ds_write_b128 v230, v[218:221]
    ds_read_b64_tr_b16 v[222:223], v231
    ds_read_b64_tr_b16 v[224:225], v231 offset:512
    buffer_store_dwordx4 v[214:217], v232, s[20:23], s32 offen sc1
    s_waitcnt lgkmcnt(0)
    buffer_store_dwordx4 v[222:225], v233, s[20:23], s32 offen sc1
    v_readfirstlane_b32 s26, v234
    s_nop 3
    s_and_b32 s26, s26, 0xffffffe0
    s_add_u32 s26, s26, 32
    s_waitcnt vmcnt(4)
    s_add_u32 s34, s26, 2
    v_mov_b32 v236, s34
    s_barrier
    buffer_store_dword v236, v238, s[60:63], 0 offen sc1
    buffer_load_dwordx4 a[0:3], v180, s[8:11], s58 offen
    buffer_load_dwordx4 a[4:7], v180, s[8:11], s58 offen offset:64
    buffer_load_dwordx4 a[8:11], v180, s[8:11], s58 offen offset:128
    buffer_load_dwordx4 a[12:15], v180, s[8:11], s58 offen offset:192
    s_add_u32 s58, s58, 0x1000
    buffer_load_dwordx4 a[16:19], v180, s[8:11], s58 offen
    buffer_load_dwordx4 a[20:23], v180, s[8:11], s58 offen offset:64
    buffer_load_dwordx4 a[24:27], v180, s[8:11], s58 offen offset:128
    buffer_load_dwordx4 a[28:31], v180, s[8:11], s58 offen offset:192
    s_add_u32 s58, s58, 0x1000
    buffer_load_dwordx4 a[32:35], v180, s[8:11], s58 offen
    buffer_load_dwordx4 a[36:39], v180, s[8:11], s58 offen offset:64
    buffer_load_dwordx4 a[40:43], v180, s[8:11], s58 offen offset:128
    buffer_load_dwordx4 a[44:47], v180, s[8:11], s58 offen offset:192
    s_add_u32 s58, s58, 0x1000
    buffer_load_dwordx4 a[48:51], v180, s[8:11], s58 offen
    buffer_load_dwordx4 a[52:55], v180, s[8:11], s58 offen offset:64
    buffer_load_dwordx4 a[56:59], v180, s[8:11], s58 offen offset:128
    buffer_load_dwordx4 a[60:63], v180, s[8:11], s58 offen offset:192
    s_add_u32 s58, s58, 0x1000
    v_mov_b32 v168, 0x3f803f80
    v_mov_b32 v169, 0x3f803f80
    v_mov_b32 v170, 0x3f803f80
    v_mov_b32 v171, 0x3f803f80
    v_mov_b32 v136, 0
    v_mov_b32 v137, 0
    v_mov_b32 v138, 0
    v_mov_b32 v139, 0
    v_mov_b32 v140, 0
    v_mov_b32 v141, 0xff800000
    v_mov_b32 v142, 0xff800000
    v_mov_b32 v143, 0xff800000
    v_mov_b32 v148, 0
    v_mov_b32 v149, 0
    v_mov_b32 v150, 0
    v_mov_b32 v151, 0
    v_lshlrev_b32 v172, 4, v175
    v_lshlrev_b32 v173, 4, v175
    s_add_u32 s33, s26, 2
    s_cmp_eq_u32 s28, 3
    s_cbranch_scc1 L_w3a
    s_waitcnt vmcnt(17)
    s_branch L_w3d
L_w3a:
    v_lshlrev_b32 v166, 2, v175
    v_lshrrev_b32 v167, 3, v175
    v_lshl_add_u32 v166, v167, 12, v166
    s_mov_b32 s37, 0
L_poll8:
    s_add_u32 s55, s55, 1
    buffer_load_dword v167, v166, s[60:63], 0 offen sc1
    s_waitcnt vmcnt(0)
    v_subrev_u32 v167, s33, v167
    v_cmp_le_u32 vcc, 32, v167
    s_nop 4
    s_and_b32 s35, vcc_lo, 0xff
    s_cmp_eq_u32 s35, 0
    s_cbranch_scc1 L_poll8_done
    s_add_u32 s37, s37, 1
    s_cmp_lt_u32 s37, 0x40000
    s_cbranch_scc1 L_poll8
L_poll8_done:
L_w3d:
    s_add_u32 s34, s26, 4
    v_mov_b32 v236, s34
    s_barrier
    buffer_store_dword v236, v238, s[60:63], 0 offen sc1
    v_add_u32 v228, 0x800, v228
    v_add_u32 v229, 0x400, v229
    s_mov_b32 s32, 0x40000
    s_add_u32 s34, s26, 4
    s_add_u32 s33, s26, 3
    s_mov_b32 m0, s59
    s_nop 0
    global_load_lds_dwordx4 v176, s[6:7] sc1
    global_load_lds_dwordx4 v176, s[6:7] offset:1024 sc1
    global_load_lds_dwordx4 v176, s[6:7] offset:2048 sc1
    global_load_lds_dwordx4 v176, s[6:7] offset:3072 sc1
    s_add_u32 m0, m0, 0x4000
    s_add_u32 s6, s6, 0x4000
    s_addc_u32 s7, s7, 0
    s_nop 0
    global_load_lds_dwordx4 v176, s[6:7] sc1
    global_load_lds_dwordx4 v176, s[6:7] offset:1024 sc1
    global_load_lds_dwordx4 v176, s[6:7] offset:2048 sc1
    global_load_lds_dwordx4 v176, s[6:7] offset:3072 sc1
    s_mov_b32 s31, 0x40000
    buffer_load_dwordx4 v[180:183], v226, s[12:15], s31 offen
    buffer_load_dwordx4 v[184:187], v226, s[12:15], s31 offen offset:16
    buffer_load_dwordx4 v[188:191], v227, s[16:19], s31 offen
    buffer_load_dwordx4 v[192:195], v227, s[16:19], s31 offen offset:16
    s_mov_b32 s31, 0x50000
    s_add_u32 s24, s24, 0x10000
    s_addc_u32 s25, s25, 0
    s_xor_b32 s29, s29, 0x10000
    s_mov_b32 s30, 14
    s_waitcnt vmcnt(8)
    s_barrier
    ds_read_b128 a[64:67], v176
    ds_read_b128 a[68:71], v176 offset:1024
    ds_read_b128 a[72:75], v176 offset:2048
    ds_read_b128 a[76:79], v176 offset:3072
    ds_read_b128 a[80:83], v176 offset:4096
    ds_read_b128 a[84:87], v176 offset:5120
    ds_read_b128 a[88:91], v176 offset:6144
    ds_read_b128 a[92:95], v176 offset:7168
    ds_read_b128 a[128:131], v176 offset:8192
    ds_read_b128 a[132:135], v176 offset:9216
    ds_read_b128 a[136:139], v176 offset:10240
    ds_read_b128 a[140:143], v176 offset:11264
    s_waitcnt lgkmcnt(0)
    v_mfma_f32_16x16x32_bf16 v[128:131], a[64:67], a[0:3], 0
    v_exp_f32 v141, v141
    s_add_u32 m0, m0, 0x4000
    s_add_u32 s6, s6, 0x4000
    s_addc_u32 s7, s7, 0
    v_mfma_f32_16x16x32_bf16 v[128:131], a[68:71], a[4:7], v[128:131]
    ds_read_b128 a[144:147], v173 offset:12288
    v_cvt_pk_bf16_f32 v150, v140, v141
    v_mfma_f32_16x16x32_bf16 v[128:131], a[72:75], a[8:11], v[128:131]
    v_exp_f32 v142, v142
    v_mfma_f32_16x16x32_bf16 v[128:131], a[76:79], a[12:15], v[128:131]
    ds_read_b128 a[148:151], v173 offset:13312
    v_mfma_f32_16x16x32_bf16 v[132:135], a[80:83], a[0:3], 0
    v_exp_f32 v143, v143
    v_mfma_f32_16x16x32_bf16 v[132:135], a[84:87], a[4:7], v[132:135]
    ds_read_b128 a[152:155], v173 offset:14336
    v_cvt_pk_bf16_f32 v151, v142, v143
    v_mfma_f32_16x16x32_bf16 v[132:135], a[88:91], a[8:11], v[132:135]
    global_load_lds_dwordx4 v176, s[6:7] sc1
    v_mfma_f32_16x16x32_bf16 v[132:135], a[92:95], a[12:15], v[132:135]
    v_exp_f32 v128, v128
    v_mfma_f32_16x16x32_bf16 v[96:99], v[168:171], v[148:151], 0
    ds_read_b128 a[156:159], v173 offset:15360
    v_mfma_f32_16x16x32_bf16 v[100:103], v[168:171], v[148:151], 0
    v_exp_f32 v129, v129
    v_mfma_f32_16x16x32_bf16 v[104:107], v[168:171], v[148:151], 0
    v_cvt_pk_bf16_f32 v144, v128, v129
    v_mfma_f32_16x16x32_bf16 v[108:111], v[168:171], v[148:151], 0
    v_exp_f32 v130, v130
    v_mfma_f32_16x16x32_bf16 v[112:115], v[168:171], v[148:151], 0
    global_load_lds_dwordx4 v176, s[6:7] offset:1024 sc1
    v_mfma_f32_16x16x32_bf16 v[116:119], v[168:171], v[148:151], 0
    v_exp_f32 v131, v131
    v_mfma_f32_16x16x32_bf16 v[120:123], v[168:171], v[148:151], 0
    v_cvt_pk_bf16_f32 v145, v130, v131
    v_mfma_f32_16x16x32_bf16 v[124:127], v[168:171], v[148:151], 0
    v_exp_f32 v132, v132
    v_mfma_f32_16x16x32_bf16 v[164:167], v[168:171], v[148:151], 0
    global_load_lds_dwordx4 v176, s[6:7] offset:2048 sc1
    s_waitcnt vmcnt(7)
    s_barrier
    v_mfma_f32_16x16x32_bf16 v[136:139], a[64:67], a[16:19], 0
    v_exp_f32 v133, v133
    v_mfma_f32_16x16x32_bf16 v[136:139], a[68:71], a[20:23], v[136:139]
    ds_read_b128 a[96:99], v172 offset:16384
    v_cvt_pk_bf16_f32 v146, v132, v133
    v_mfma_f32_16x16x32_bf16 v[136:139], a[72:75], a[24:27], v[136:139]
    v_exp_f32 v134, v134
    v_mfma_f32_16x16x32_bf16 v[136:139], a[76:79], a[28:31], v[136:139]
    global_load_lds_dwordx4 v176, s[6:7] offset:3072 sc1
    v_mfma_f32_16x16x32_bf16 v[140:143], a[80:83], a[16:19], 0
    v_exp_f32 v135, v135
    s_add_u32 m0, m0, 0x4000
    s_add_u32 s6, s6, 0x4000
    s_addc_u32 s7, s7, 0
    v_mfma_f32_16x16x32_bf16 v[140:143], a[84:87], a[20:23], v[140:143]
    ds_read_b128 a[100:103], v172 offset:17408
    v_cvt_pk_bf16_f32 v147, v134, v135
    v_mfma_f32_16x16x32_bf16 v[140:143], a[88:91], a[24:27], v[140:143]
    global_load_lds_dwordx4 v176, s[6:7] sc1
    v_mfma_f32_16x16x32_bf16 v[140:143], a[92:95], a[28:31], v[140:143]
    v_exp_f32 v136, v136
    v_mfma_f32_16x16x32_bf16 v[0:3], a[128:131], v[144:147], 0
    global_load_lds_dwordx4 v176, s[6:7] offset:1024 sc1
    v_mfma_f32_16x16x32_bf16 v[4:7], a[132:135], v[144:147], 0
    v_exp_f32 v137, v137
    v_mfma_f32_16x16x32_bf16 v[8:11], a[136:139], v[144:147], 0
    ds_read_b128 a[104:107], v172 offset:18432
    v_cvt_pk_bf16_f32 v148, v136, v137
    v_mfma_f32_16x16x32_bf16 v[12:15], a[140:143], v[144:147], 0
    v_exp_f32 v138, v138
    s_waitcnt lgkmcnt(1)
    v_mfma_f32_16x16x32_bf16 v[16:19], a[144:147], v[144:147], 0
    global_load_lds_dwordx4 v176, s[6:7] offset:2048 sc1
    v_mfma_f32_16x16x32_bf16 v[20:23], a[148:151], v[144:147], 0
    v_exp_f32 v139, v139
    v_mfma_f32_16x16x32_bf16 v[24:27], a[152:155], v[144:147], 0
    ds_read_b128 a[108:111], v172 offset:19456
    v_cvt_pk_bf16_f32 v149, v138, v139
    v_mfma_f32_16x16x32_bf16 v[28:31], a[156:159], v[144:147], 0
    v_exp_f32 v140, v140
    v_mfma_f32_16x16x32_bf16 v[152:155], v[168:171], v[144:147], 0
    global_load_lds_dwordx4 v176, s[6:7] offset:3072 sc1
    v_mfma_f32_16x16x32_bf16 v[128:131], a[64:67], a[32:35], 0
    v_exp_f32 v141, v141
    s_mov_b32 m0, s29
    v_mfma_f32_16x16x32_bf16 v[128:131], a[68:71], a[36:39], v[128:131]
    ds_read_b128 a[112:115], v172 offset:20480
    v_cvt_pk_bf16_f32 v150, v140, v141
    v_mfma_f32_16x16x32_bf16 v[128:131], a[72:75], a[40:43], v[128:131]
    v_exp_f32 v142, v142
    v_mfma_f32_16x16x32_bf16 v[128:131], a[76:79], a[44:47], v[128:131]
    global_load_lds_dwordx4 v176, s[24:25] sc1
    v_mfma_f32_16x16x32_bf16 v[132:135], a[80:83], a[32:35], 0
    v_exp_f32 v143, v143
    v_mfma_f32_16x16x32_bf16 v[132:135], a[84:87], a[36:39], v[132:135]
    ds_read_b128 a[116:119], v172 offset:21504
    v_cvt_pk_bf16_f32 v151, v142, v143
    v_mfma_f32_16x16x32_bf16 v[132:135], a[88:91], a[40:43], v[132:135]
    global_load_lds_dwordx4 v176, s[24:25] offset:1024 sc1
    v_mfma_f32_16x16x32_bf16 v[132:135], a[92:95], a[44:47], v[132:135]
    v_exp_f32 v128, v128
    v_mfma_f32_16x16x32_bf16 v[32:35], a[128:131], v[148:151], 0
    global_load_lds_dwordx4 v176, s[24:25] offset:2048 sc1
    v_mfma_f32_16x16x32_bf16 v[36:39], a[132:135], v[148:151], 0
    v_exp_f32 v129, v129
    v_mfma_f32_16x16x32_bf16 v[40:43], a[136:139], v[148:151], 0
    ds_read_b128 a[120:123], v172 offset:22528
    v_cvt_pk_bf16_f32 v144, v128, v129
    v_mfma_f32_16x16x32_bf16 v[44:47], a[140:143], v[148:151], 0
    v_exp_f32 v130, v130
    v_mfma_f32_16x16x32_bf16 v[48:51], a[144:147], v[148:151], 0
    global_load_lds_dwordx4 v176, s[24:25] offset:3072 sc1
    v_mfma_f32_16x16x32_bf16 v[52:55], a[148:151], v[148:151], 0
    v_exp_f32 v131, v131
    v_mfma_f32_16x16x32_bf16 v[56:59], a[152:155], v[148:151], 0
    ds_read_b128 a[124:127], v172 offset:23552
    v_cvt_pk_bf16_f32 v145, v130, v131
    v_mfma_f32_16x16x32_bf16 v[60:63], a[156:159], v[148:151], 0
    v_exp_f32 v132, v132
    s_add_u32 m0, m0, 0x1000
    v_mfma_f32_16x16x32_bf16 v[156:159], v[168:171], v[148:151], 0
    global_load_lds_dwordx4 v177, s[24:25] sc1
    v_mfma_f32_16x16x32_bf16 v[136:139], a[64:67], a[48:51], 0
    v_exp_f32 v133, v133
    v_mfma_f32_16x16x32_bf16 v[136:139], a[68:71], a[52:55], v[136:139]
    ds_read_b128 a[160:163], v172 offset:24576
    v_cvt_pk_bf16_f32 v146, v132, v133
    v_mfma_f32_16x16x32_bf16 v[136:139], a[72:75], a[56:59], v[136:139]
    v_exp_f32 v134, v134
    v_mfma_f32_16x16x32_bf16 v[136:139], a[76:79], a[60:63], v[136:139]
    global_load_lds_dwordx4 v177, s[24:25] offset:1024 sc1
    v_mfma_f32_16x16x32_bf16 v[140:143], a[80:83], a[48:51], 0
    v_exp_f32 v135, v135
    v_mfma_f32_16x16x32_bf16 v[140:143], a[84:87], a[52:55], v[140:143]
    ds_read_b128 a[164:167], v172 offset:25600
    v_cvt_pk_bf16_f32 v147, v134, v135
    v_mfma_f32_16x16x32_bf16 v[140:143], a[88:91], a[56:59], v[140:143]
    global_load_lds_dwordx4 v177, s[24:25] offset:2048 sc1
    v_mfma_f32_16x16x32_bf16 v[140:143], a[92:95], a[60:63], v[140:143]
    v_exp_f32 v136, v136
    v_mfma_f32_16x16x32_bf16 v[64:67], a[128:131], v[144:147], 0
    global_load_lds_dwordx4 v177, s[24:25] offset:3072 sc1
    v_mfma_f32_16x16x32_bf16 v[68:71], a[132:135], v[144:147], 0
    v_exp_f32 v137, v137
    v_mfma_f32_16x16x32_bf16 v[72:75], a[136:139], v[144:147], 0
    ds_read_b128 a[168:171], v172 offset:26624
    v_cvt_pk_bf16_f32 v148, v136, v137
    v_mfma_f32_16x16x32_bf16 v[76:79], a[140:143], v[144:147], 0
    v_exp_f32 v138, v138
    s_add_u32 m0, m0, 0x1000
    v_mfma_f32_16x16x32_bf16 v[80:83], a[144:147], v[144:147], 0
    global_load_lds_dwordx4 v178, s[24:25] sc1
    v_mfma_f32_16x16x32_bf16 v[84:87], a[148:151], v[144:147], 0
    v_exp_f32 v139, v139
    v_mfma_f32_16x16x32_bf16 v[88:91], a[152:155], v[144:147], 0
    ds_read_b128 a[172:175], v172 offset:27648
    v_cvt_pk_bf16_f32 v149, v138, v139
    v_mfma_f32_16x16x32_bf16 v[92:95], a[156:159], v[144:147], 0
    v_exp_f32 v140, v140
    v_mfma_f32_16x16x32_bf16 v[160:163], v[168:171], v[144:147], 0
    global_load_lds_dwordx4 v178, s[24:25] offset:1024 sc1
    v_mfma_f32_16x16x32_bf16 v[128:131], a[96:99], a[0:3], 0
    v_exp_f32 v141, v141
    v_mfma_f32_16x16x32_bf16 v[128:131], a[100:103], a[4:7], v[128:131]
    ds_read_b128 a[176:179], v173 offset:28672
    v_cvt_pk_bf16_f32 v150, v140, v141
    s_waitcnt lgkmcnt(2)
    v_mfma_f32_16x16x32_bf16 v[128:131], a[104:107], a[8:11], v[128:131]
    v_exp_f32 v142, v142
    v_mfma_f32_16x16x32_bf16 v[128:131], a[108:111], a[12:15], v[128:131]
    ds_read_b128 a[180:183], v173 offset:29696
    v_mfma_f32_16x16x32_bf16 v[132:135], a[112:115], a[0:3], 0
    v_exp_f32 v143, v143
    v_mfma_f32_16x16x32_bf16 v[132:135], a[116:119], a[4:7], v[132:135]
    ds_read_b128 a[184:187], v173 offset:30720
    v_cvt_pk_bf16_f32 v151, v142, v143
    v_mfma_f32_16x16x32_bf16 v[132:135], a[120:123], a[8:11], v[132:135]
    global_load_lds_dwordx4 v178, s[24:25] offset:2048 sc1
    v_mfma_f32_16x16x32_bf16 v[132:135], a[124:127], a[12:15], v[132:135]
    v_exp_f32 v128, v128
    v_mfma_f32_16x16x32_bf16 v[96:99], a[128:131], v[148:151], v[96:99]
    ds_read_b128 a[188:191], v173 offset:31744
    v_mfma_f32_16x16x32_bf16 v[100:103], a[132:135], v[148:151], v[100:103]
    v_exp_f32 v129, v129
    v_mfma_f32_16x16x32_bf16 v[104:107], a[136:139], v[148:151], v[104:107]
    v_cvt_pk_bf16_f32 v144, v128, v129
    v_mfma_f32_16x16x32_bf16 v[108:111], a[140:143], v[148:151], v[108:111]
    v_exp_f32 v130, v130
    v_mfma_f32_16x16x32_bf16 v[112:115], a[144:147], v[148:151], v[112:115]
    global_load_lds_dwordx4 v178, s[24:25] offset:3072 sc1
    v_mfma_f32_16x16x32_bf16 v[116:119], a[148:151], v[148:151], v[116:119]
    v_exp_f32 v131, v131
    v_mfma_f32_16x16x32_bf16 v[120:123], a[152:155], v[148:151], v[120:123]
    v_cvt_pk_bf16_f32 v145, v130, v131
    v_mfma_f32_16x16x32_bf16 v[124:127], a[156:159], v[148:151], v[124:127]
    v_exp_f32 v132, v132
    s_add_u32 m0, m0, 0x1000
    v_mfma_f32_16x16x32_bf16 v[164:167], v[168:171], v[148:151], v[164:167]
    global_load_lds_dwordx4 v179, s[24:25] sc1
    s_waitcnt vmcnt(17)
    s_barrier
    v_mfma_f32_16x16x32_bf16 v[136:139], a[96:99], a[16:19], 0
    v_exp_f32 v133, v133
    v_mfma_f32_16x16x32_bf16 v[136:139], a[100:103], a[20:23], v[136:139]
    ds_read_b128 a[64:67], v172 offset:32768
    v_cvt_pk_bf16_f32 v146, v132, v133
    v_mfma_f32_16x16x32_bf16 v[136:139], a[104:107], a[24:27], v[136:139]
    v_exp_f32 v134, v134
    v_mfma_f32_16x16x32_bf16 v[136:139], a[108:111], a[28:31], v[136:139]
    global_load_lds_dwordx4 v179, s[24:25] offset:1024 sc1
    v_mfma_f32_16x16x32_bf16 v[140:143], a[112:115], a[16:19], 0
    v_exp_f32 v135, v135
    v_mfma_f32_16x16x32_bf16 v[140:143], a[116:119], a[20:23], v[140:143]
    ds_read_b128 a[68:71], v172 offset:33792
    v_cvt_pk_bf16_f32 v147, v134, v135
    v_mfma_f32_16x16x32_bf16 v[140:143], a[120:123], a[24:27], v[140:143]
    global_load_lds_dwordx4 v179, s[24:25] offset:2048 sc1
    v_mfma_f32_16x16x32_bf16 v[140:143], a[124:127], a[28:31], v[140:143]
    v_exp_f32 v136, v136
    v_mfma_f32_16x16x32_bf16 v[0:3], a[160:163], v[144:147], v[0:3]
    global_load_lds_dwordx4 v179, s[24:25] offset:3072 sc1
    v_mfma_f32_16x16x32_bf16 v[4:7], a[164:167], v[144:147], v[4:7]
    v_exp_f32 v137, v137
    s_add_u32 s24, s24, 0x10000
    s_addc_u32 s25, s25, 0
    v_mfma_f32_16x16x32_bf16 v[8:11], a[168:171], v[144:147], v[8:11]
    ds_read_b128 a[72:75], v172 offset:34816
    v_cvt_pk_bf16_f32 v148, v136, v137
    s_waitcnt lgkmcnt(2)
    v_mfma_f32_16x16x32_bf16 v[12:15], a[172:175], v[144:147], v[12:15]
    v_exp_f32 v138, v138
    v_mfma_f32_16x16x32_bf16 v[16:19], a[176:179], v[144:147], v[16:19]
    buffer_load_dwordx2 v[234:235], v237, s[60:63], 0 offen sc1
    v_mfma_f32_16x16x32_bf16 v[20:23], a[180:183], v[144:147], v[20:23]
    v_exp_f32 v139, v139
    v_mfma_f32_16x16x32_bf16 v[24:27], a[184:187], v[144:147], v[24:27]
    ds_read_b128 a[76:79], v172 offset:35840
    v_cvt_pk_bf16_f32 v149, v138, v139
    v_mfma_f32_16x16x32_bf16 v[28:31], a[188:191], v[144:147], v[28:31]
    v_exp_f32 v140, v140
    v_mfma_f32_16x16x32_bf16 v[152:155], v[168:171], v[144:147], v[152:155]
    ds_read_b128 v[196:199], v228
    v_mfma_f32_16x16x32_bf16 v[128:131], a[96:99], a[32:35], 0
    v_exp_f32 v141, v141
    v_mfma_f32_16x16x32_bf16 v[128:131], a[100:103], a[36:39], v[128:131]
    ds_read_b128 a[80:83], v172 offset:36864
    v_cvt_pk_bf16_f32 v150, v140, v141
    v_mfma_f32_16x16x32_bf16 v[128:131], a[104:107], a[40:43], v[128:131]
    v_exp_f32 v142, v142
    v_mfma_f32_16x16x32_bf16 v[128:131], a[108:111], a[44:47], v[128:131]
    ds_read_b128 v[204:207], v228 offset:256
    v_mfma_f32_16x16x32_bf16 v[132:135], a[112:115], a[32:35], 0
    v_exp_f32 v143, v143
    v_mfma_f32_16x16x32_bf16 v[132:135], a[116:119], a[36:39], v[132:135]
    ds_read_b128 a[84:87], v172 offset:37888
    v_cvt_pk_bf16_f32 v151, v142, v143
    v_mfma_f32_16x16x32_bf16 v[132:135], a[120:123], a[40:43], v[132:135]
    ds_read_b128 v[200:203], v228 offset:16
    v_mfma_f32_16x16x32_bf16 v[132:135], a[124:127], a[44:47], v[132:135]
    v_exp_f32 v128, v128
    v_mfma_f32_16x16x32_bf16 v[32:35], a[160:163], v[148:151], v[32:35]
    ds_read_b128 v[208:211], v228 offset:272
    v_mfma_f32_16x16x32_bf16 v[36:39], a[164:167], v[148:151], v[36:39]
    v_exp_f32 v129, v129
    v_mfma_f32_16x16x32_bf16 v[40:43], a[168:171], v[148:151], v[40:43]
    ds_read_b128 a[88:91], v172 offset:38912
    v_cvt_pk_bf16_f32 v144, v128, v129
    v_mfma_f32_16x16x32_bf16 v[44:47], a[172:175], v[148:151], v[44:47]
    v_exp_f32 v130, v130
    v_mfma_f32_16x16x32_bf16 v[48:51], a[176:179], v[148:151], v[48:51]
    ds_read_b64 v[212:213], v229
    v_mfma_f32_16x16x32_bf16 v[52:55], a[180:183], v[148:151], v[52:55]
    v_exp_f32 v131, v131
    v_cvt_f32_i32 v240, v180
    v_mfma_f32_16x16x32_bf16 v[56:59], a[184:187], v[148:151], v[56:59]
    ds_read_b128 a[92:95], v172 offset:39936
    v_cvt_pk_bf16_f32 v145, v130, v131
    v_cvt_f32_i32 v241, v181
    v_mfma_f32_16x16x32_bf16 v[60:63], a[188:191], v[148:151], v[60:63]
    v_exp_f32 v132, v132
    v_cvt_f32_i32 v242, v182
    v_mfma_f32_16x16x32_bf16 v[156:159], v[168:171], v[148:151], v[156:159]
    v_cvt_f32_i32 v243, v183
    v_cvt_f32_i32 v244, v184
    v_cvt_f32_i32 v245, v185
    v_mfma_f32_16x16x32_bf16 v[136:139], a[96:99], a[48:51], 0
    v_exp_f32 v133, v133
    v_cvt_f32_i32 v246, v186
    v_mfma_f32_16x16x32_bf16 v[136:139], a[100:103], a[52:55], v[136:139]
    ds_read_b128 a[128:131], v172 offset:40960
    v_cvt_pk_bf16_f32 v146, v132, v133
    v_cvt_f32_i32 v247, v187
    v_mfma_f32_16x16x32_bf16 v[136:139], a[104:107], a[56:59], v[136:139]
    v_exp_f32 v134, v134
    v_mfma_f32_16x16x32_bf16 v[136:139], a[108:111], a[60:63], v[136:139]
    buffer_load_dwordx4 v[180:183], v226, s[12:15], s31 offen
    v_mfma_f32_16x16x32_bf16 v[140:143], a[112:115], a[48:51], 0
    v_exp_f32 v135, v135
    v_mfma_f32_16x16x32_bf16 v[140:143], a[116:119], a[52:55], v[140:143]
    ds_read_b128 a[132:135], v172 offset:41984
    v_cvt_pk_bf16_f32 v147, v134, v135
    v_mfma_f32_16x16x32_bf16 v[140:143], a[120:123], a[56:59], v[140:143]
    buffer_load_dwordx4 v[184:187], v226, s[12:15], s31 offen offset:16
    v_mfma_f32_16x16x32_bf16 v[140:143], a[124:127], a[60:63], v[140:143]
    v_exp_f32 v136, v136
    v_cvt_f32_i32 v248, v188
    v_mfma_f32_16x16x32_bf16 v[64:67], a[160:163], v[144:147], v[64:67]
    v_cvt_f32_i32 v249, v189
    v_cvt_f32_i32 v250, v190
    v_cvt_f32_i32 v251, v191
    v_mfma_f32_16x16x32_bf16 v[68:71], a[164:167], v[144:147], v[68:71]
    v_exp_f32 v137, v137
    v_cvt_f32_i32 v252, v192
    v_mfma_f32_16x16x32_bf16 v[72:75], a[168:171], v[144:147], v[72:75]
    ds_read_b128 a[136:139], v172 offset:43008
    v_cvt_pk_bf16_f32 v148, v136, v137
    v_cvt_f32_i32 v253, v193
    v_mfma_f32_16x16x32_bf16 v[76:79], a[172:175], v[144:147], v[76:79]
    v_exp_f32 v138, v138
    v_cvt_f32_i32 v254, v194
    v_mfma_f32_16x16x32_bf16 v[80:83], a[176:179], v[144:147], v[80:83]
    v_cvt_f32_i32 v255, v195
    v_mfma_f32_16x16x32_bf16 v[84:87], a[180:183], v[144:147], v[84:87]
    v_exp_f32 v139, v139
    v_mfma_f32_16x16x32_bf16 v[88:91], a[184:187], v[144:147], v[88:91]
    ds_read_b128 a[140:143], v172 offset:44032
    v_cvt_pk_bf16_f32 v149, v138, v139
    v_mfma_f32_16x16x32_bf16 v[92:95], a[188:191], v[144:147], v[92:95]
    v_exp_f32 v140, v140
    v_mfma_f32_16x16x32_bf16 v[160:163], v[168:171], v[144:147], v[160:163]
    buffer_load_dwordx4 v[188:191], v227, s[16:19], s31 offen
    v_mfma_f32_16x16x32_bf16 v[128:131], a[64:67], a[0:3], 0
    v_exp_f32 v141, v141
    s_waitcnt lgkmcnt(1)
    v_mfma_f32_16x16x32_bf16 v[128:131], a[68:71], a[4:7], v[128:131]
    ds_read_b128 a[144:147], v173 offset:45056
    v_cvt_pk_bf16_f32 v150, v140, v141
    v_mfma_f32_16x16x32_bf16 v[128:131], a[72:75], a[8:11], v[128:131]
    v_exp_f32 v142, v142
    v_mfma_f32_16x16x32_bf16 v[128:131], a[76:79], a[12:15], v[128:131]
    ds_read_b128 a[148:151], v173 offset:46080
    v_mfma_f32_16x16x32_bf16 v[132:135], a[80:83], a[0:3], 0
    v_exp_f32 v143, v143
    v_mfma_f32_16x16x32_bf16 v[132:135], a[84:87], a[4:7], v[132:135]
    ds_read_b128 a[152:155], v173 offset:47104
    v_cvt_pk_bf16_f32 v151, v142, v143
    v_mfma_f32_16x16x32_bf16 v[132:135], a[88:91], a[8:11], v[132:135]
    buffer_load_dwordx4 v[192:195], v227, s[16:19], s31 offen offset:16
    v_mfma_f32_16x16x32_bf16 v[132:135], a[92:95], a[12:15], v[132:135]
    v_exp_f32 v128, v128
    v_fma_f32 v240, v240, v196, v204
    s_add_u32 s31, s31, 0x10000
    v_mfma_f32_16x16x32_bf16 v[96:99], a[160:163], v[148:151], v[96:99]
    ds_read_b128 a[156:159], v173 offset:48128
    v_fma_f32 v241, v241, v197, v205
    v_fma_f32 v242, v242, v198, v206
    v_mfma_f32_16x16x32_bf16 v[100:103], a[164:167], v[148:151], v[100:103]
    v_exp_f32 v129, v129
    v_fma_f32 v243, v243, v199, v207
    v_mfma_f32_16x16x32_bf16 v[104:107], a[168:171], v[148:151], v[104:107]
    v_cvt_pk_bf16_f32 v144, v128, v129
    v_fma_f32 v244, v244, v200, v208
    v_fma_f32 v245, v245, v201, v209
    v_mfma_f32_16x16x32_bf16 v[108:111], a[172:175], v[148:151], v[108:111]
    v_exp_f32 v130, v130
    v_fma_f32 v246, v246, v202, v210
    v_mfma_f32_16x16x32_bf16 v[112:115], a[176:179], v[148:151], v[112:115]
    v_fma_f32 v247, v247, v203, v211
    v_cvt_pk_bf16_f32 v214, v240, v241
    v_cvt_pk_bf16_f32 v215, v242, v243
    v_mfma_f32_16x16x32_bf16 v[116:119], a[180:183], v[148:151], v[116:119]
    v_exp_f32 v131, v131
    v_cvt_pk_bf16_f32 v216, v244, v245
    v_mfma_f32_16x16x32_bf16 v[120:123], a[184:187], v[148:151], v[120:123]
    v_cvt_pk_bf16_f32 v145, v130, v131
    v_cvt_pk_bf16_f32 v217, v246, v247
    v_fma_f32 v248, v248, v212, v213
    v_mfma_f32_16x16x32_bf16 v[124:127], a[188:191], v[148:151], v[124:127]
    v_exp_f32 v132, v132
    v_fma_f32 v249, v249, v212, v213
    v_mfma_f32_16x16x32_bf16 v[164:167], v[168:171], v[148:151], v[164:167]
    v_fma_f32 v250, v250, v212, v213
    v_fma_f32 v251, v251, v212, v213
    v_fma_f32 v252, v252, v212, v213
    s_waitcnt vmcnt(21)
    s_barrier
    v_mfma_f32_16x16x32_bf16 v[136:139], a[64:67], a[16:19], 0
    v_exp_f32 v133, v133
    v_fma_f32 v253, v253, v212, v213
    v_mfma_f32_16x16x32_bf16 v[136:139], a[68:71], a[20:23], v[136:139]
    ds_read_b128 a[96:99], v172 offset:49152
    v_cvt_pk_bf16_f32 v146, v132, v133
    v_fma_f32 v254, v254, v212, v213
    v_mfma_f32_16x16x32_bf16 v[136:139], a[72:75], a[24:27], v[136:139]
    v_exp_f32 v134, v134
    v_fma_f32 v255, v255, v212, v213
    v_mfma_f32_16x16x32_bf16 v[136:139], a[76:79], a[28:31], v[136:139]
    v_cvt_pk_bf16_f32 v218, v248, v249
    v_cvt_pk_bf16_f32 v219, v250, v251
    v_cvt_pk_bf16_f32 v220, v252, v253
    v_mfma_f32_16x16x32_bf16 v[140:143], a[80:83], a[16:19], 0
    v_exp_f32 v135, v135
    v_cvt_pk_bf16_f32 v221, v254, v255
    v_mfma_f32_16x16x32_bf16 v[140:143], a[84:87], a[20:23], v[140:143]
    ds_read_b128 a[100:103], v172 offset:50176
    v_cvt_pk_bf16_f32 v147, v134, v135
    v_mfma_f32_16x16x32_bf16 v[140:143], a[88:91], a[24:27], v[140:143]
    ds_write_b128 v230, v[218:221]
    v_mfma_f32_16x16x32_bf16 v[140:143], a[92:95], a[28:31], v[140:143]
    v_exp_f32 v136, v136
    v_mfma_f32_16x16x32_bf16 v[0:3], a[128:131], v[144:147], v[0:3]
    v_mfma_f32_16x16x32_bf16 v[4:7], a[132:135], v[144:147], v[4:7]
    v_exp_f32 v137, v137
    v_mfma_f32_16x16x32_bf16 v[8:11], a[136:139], v[144:147], v[8:11]
    ds_read_b128 a[104:107], v172 offset:51200
    v_cvt_pk_bf16_f32 v148, v136, v137
    s_waitcnt lgkmcnt(3)
    v_mfma_f32_16x16x32_bf16 v[12:15], a[140:143], v[144:147], v[12:15]
    v_exp_f32 v138, v138
    v_mfma_f32_16x16x32_bf16 v[16:19], a[144:147], v[144:147], v[16:19]
    ds_read_b64_tr_b16 v[222:223], v231
    v_mfma_f32_16x16x32_bf16 v[20:23], a[148:151], v[144:147], v[20:23]
    v_exp_f32 v139, v139
    v_mfma_f32_16x16x32_bf16 v[24:27], a[152:155], v[144:147], v[24:27]
    ds_read_b128 a[108:111], v172 offset:52224
    v_cvt_pk_bf16_f32 v149, v138, v139
    v_mfma_f32_16x16x32_bf16 v[28:31], a[156:159], v[144:147], v[28:31]
    v_exp_f32 v140, v140
    v_mfma_f32_16x16x32_bf16 v[152:155], v[168:171], v[144:147], v[152:155]
    ds_read_b64_tr_b16 v[224:225], v231 offset:512
    v_mfma_f32_16x16x32_bf16 v[128:131], a[64:67], a[32:35], 0
    v_exp_f32 v141, v141
    v_mfma_f32_16x16x32_bf16 v[128:131], a[68:71], a[36:39], v[128:131]
    ds_read_b128 a[112:115], v172 offset:53248
    v_cvt_pk_bf16_f32 v150, v140, v141
    v_mfma_f32_16x16x32_bf16 v[128:131], a[72:75], a[40:43], v[128:131]
    v_exp_f32 v142, v142
    v_mfma_f32_16x16x32_bf16 v[128:131], a[76:79], a[44:47], v[128:131]
    buffer_store_dwordx4 v[214:217], v232, s[20:23], s32 offen sc1
    v_mfma_f32_16x16x32_bf16 v[132:135], a[80:83], a[32:35], 0
    v_exp_f32 v143, v143
    v_mfma_f32_16x16x32_bf16 v[132:135], a[84:87], a[36:39], v[132:135]
    ds_read_b128 a[116:119], v172 offset:54272
    v_cvt_pk_bf16_f32 v151, v142, v143
    v_mfma_f32_16x16x32_bf16 v[132:135], a[88:91], a[40:43], v[132:135]
    v_mfma_f32_16x16x32_bf16 v[132:135], a[92:95], a[44:47], v[132:135]
    v_exp_f32 v128, v128
    v_mfma_f32_16x16x32_bf16 v[32:35], a[128:131], v[148:151], v[32:35]
    v_mfma_f32_16x16x32_bf16 v[36:39], a[132:135], v[148:151], v[36:39]
    v_exp_f32 v129, v129
    v_mfma_f32_16x16x32_bf16 v[40:43], a[136:139], v[148:151], v[40:43]
    ds_read_b128 a[120:123], v172 offset:55296
    v_cvt_pk_bf16_f32 v144, v128, v129
    v_mfma_f32_16x16x32_bf16 v[44:47], a[140:143], v[148:151], v[44:47]
    v_exp_f32 v130, v130
    v_mfma_f32_16x16x32_bf16 v[48:51], a[144:147], v[148:151], v[48:51]
    s_waitcnt lgkmcnt(1)
    buffer_store_dwordx4 v[222:225], v233, s[20:23], s32 offen sc1
    v_mfma_f32_16x16x32_bf16 v[52:55], a[148:151], v[148:151], v[52:55]
    v_exp_f32 v131, v131
    v_mfma_f32_16x16x32_bf16 v[56:59], a[152:155], v[148:151], v[56:59]
    ds_read_b128 a[124:127], v172 offset:56320
    v_cvt_pk_bf16_f32 v145, v130, v131
    s_add_u32 s32, s32, 0x10000
    v_mfma_f32_16x16x32_bf16 v[60:63], a[156:159], v[148:151], v[60:63]
    v_exp_f32 v132, v132
    v_mfma_f32_16x16x32_bf16 v[156:159], v[168:171], v[148:151], v[156:159]
    v_add_u32 v228, 0x200, v228
    v_add_u32 v229, 0x100, v229
    v_mfma_f32_16x16x32_bf16 v[136:139], a[64:67], a[48:51], 0
    v_exp_f32 v133, v133
    v_mfma_f32_16x16x32_bf16 v[136:139], a[68:71], a[52:55], v[136:139]
    ds_read_b128 a[160:163], v172 offset:57344
    v_cvt_pk_bf16_f32 v146, v132, v133
    v_mfma_f32_16x16x32_bf16 v[136:139], a[72:75], a[56:59], v[136:139]
    v_exp_f32 v134, v134
    v_mfma_f32_16x16x32_bf16 v[136:139], a[76:79], a[60:63], v[136:139]
    v_mfma_f32_16x16x32_bf16 v[140:143], a[80:83], a[48:51], 0
    v_exp_f32 v135, v135
    v_mfma_f32_16x16x32_bf16 v[140:143], a[84:87], a[52:55], v[140:143]
    ds_read_b128 a[164:167], v172 offset:58368
    v_cvt_pk_bf16_f32 v147, v134, v135
    v_mfma_f32_16x16x32_bf16 v[140:143], a[88:91], a[56:59], v[140:143]
    v_mfma_f32_16x16x32_bf16 v[140:143], a[92:95], a[60:63], v[140:143]
    v_exp_f32 v136, v136
    v_mfma_f32_16x16x32_bf16 v[64:67], a[128:131], v[144:147], v[64:67]
    v_mfma_f32_16x16x32_bf16 v[68:71], a[132:135], v[144:147], v[68:71]
    v_exp_f32 v137, v137
    v_mfma_f32_16x16x32_bf16 v[72:75], a[136:139], v[144:147], v[72:75]
    ds_read_b128 a[168:171], v172 offset:59392
    v_cvt_pk_bf16_f32 v148, v136, v137
    v_mfma_f32_16x16x32_bf16 v[76:79], a[140:143], v[144:147], v[76:79]
    v_exp_f32 v138, v138
    v_mfma_f32_16x16x32_bf16 v[80:83], a[144:147], v[144:147], v[80:83]
    v_mfma_f32_16x16x32_bf16 v[84:87], a[148:151], v[144:147], v[84:87]
    v_exp_f32 v139, v139
    v_mfma_f32_16x16x32_bf16 v[88:91], a[152:155], v[144:147], v[88:91]
    ds_read_b128 a[172:175], v172 offset:60416
    v_cvt_pk_bf16_f32 v149, v138, v139
    v_mfma_f32_16x16x32_bf16 v[92:95], a[156:159], v[144:147], v[92:95]
    v_exp_f32 v140, v140
    v_mfma_f32_16x16x32_bf16 v[160:163], v[168:171], v[144:147], v[160:163]
    v_mfma_f32_16x16x32_bf16 v[128:131], a[96:99], a[0:3], 0
    v_exp_f32 v141, v141
    v_mfma_f32_16x16x32_bf16 v[128:131], a[100:103], a[4:7], v[128:131]
    ds_read_b128 a[176:179], v173 offset:61440
    v_cvt_pk_bf16_f32 v150, v140, v141
    v_mfma_f32_16x16x32_bf16 v[128:131], a[104:107], a[8:11], v[128:131]
    v_exp_f32 v142, v142
    v_mfma_f32_16x16x32_bf16 v[128:131], a[108:111], a[12:15], v[128:131]
    ds_read_b128 a[180:183], v173 offset:62464
    v_mfma_f32_16x16x32_bf16 v[132:135], a[112:115], a[0:3], 0
    v_exp_f32 v143, v143
    v_mfma_f32_16x16x32_bf16 v[132:135], a[116:119], a[4:7], v[132:135]
    ds_read_b128 a[184:187], v173 offset:63488
    v_cvt_pk_bf16_f32 v151, v142, v143
    s_waitcnt lgkmcnt(3)
    v_mfma_f32_16x16x32_bf16 v[132:135], a[120:123], a[8:11], v[132:135]
    v_mfma_f32_16x16x32_bf16 v[132:135], a[124:127], a[12:15], v[132:135]
    v_exp_f32 v128, v128
    v_mfma_f32_16x16x32_bf16 v[96:99], a[128:131], v[148:151], v[96:99]
    ds_read_b128 a[188:191], v173 offset:64512
    v_mfma_f32_16x16x32_bf16 v[100:103], a[132:135], v[148:151], v[100:103]
    v_exp_f32 v129, v129
    v_mfma_f32_16x16x32_bf16 v[104:107], a[136:139], v[148:151], v[104:107]
    v_cvt_pk_bf16_f32 v144, v128, v129
    v_mfma_f32_16x16x32_bf16 v[108:111], a[140:143], v[148:151], v[108:111]
    v_exp_f32 v130, v130
    v_mfma_f32_16x16x32_bf16 v[112:115], a[144:147], v[148:151], v[112:115]
    v_mfma_f32_16x16x32_bf16 v[116:119], a[148:151], v[148:151], v[116:119]
    v_exp_f32 v131, v131
    v_mfma_f32_16x16x32_bf16 v[120:123], a[152:155], v[148:151], v[120:123]
    v_cvt_pk_bf16_f32 v145, v130, v131
    v_mfma_f32_16x16x32_bf16 v[124:127], a[156:159], v[148:151], v[124:127]
    v_exp_f32 v132, v132
    v_mfma_f32_16x16x32_bf16 v[164:167], v[168:171], v[148:151], v[164:167]
    s_waitcnt vmcnt(6) lgkmcnt(0)
    s_barrier
    v_xor_b32 v172, 0x10000, v172
    s_xor_b32 s29, s29, 0x10000
    s_mov_b32 m0, s29
    v_readfirstlane_b32 s35, v234
    v_mfma_f32_16x16x32_bf16 v[136:139], a[96:99], a[16:19], 0
    v_readfirstlane_b32 s36, v235
    v_exp_f32 v133, v133
    v_mfma_f32_16x16x32_bf16 v[136:139], a[100:103], a[20:23], v[136:139]
    ds_read_b128 a[64:67], v172
    v_cvt_pk_bf16_f32 v146, v132, v133
    v_mfma_f32_16x16x32_bf16 v[136:139], a[104:107], a[24:27], v[136:139]
    v_exp_f32 v134, v134
    s_sub_u32 s35, s35, s33
    s_sub_u32 s36, s36, s33
    s_max_u32 s35, s35, s36
    s_cmp_ge_u32 s35, 32
    s_cbranch_scc1 L_spin_first
L_back_first:
    v_mfma_f32_16x16x32_bf16 v[136:139], a[108:111], a[28:31], v[136:139]
    v_mov_b32 v236, s34
    v_mfma_f32_16x16x32_bf16 v[140:143], a[112:115], a[16:19], 0
    v_exp_f32 v135, v135
    v_mfma_f32_16x16x32_bf16 v[140:143], a[116:119], a[20:23], v[140:143]
    ds_read_b128 a[68:71], v172 offset:1024
    v_cvt_pk_bf16_f32 v147, v134, v135
    v_mfma_f32_16x16x32_bf16 v[140:143], a[120:123], a[24:27], v[140:143]
    buffer_store_dword v236, v238, s[60:63], 0 offen sc1
    v_mfma_f32_16x16x32_bf16 v[140:143], a[124:127], a[28:31], v[140:143]
    v_exp_f32 v136, v136
    s_add_u32 s34, s34, 1
    s_add_u32 s33, s33, 1
    v_mfma_f32_16x16x32_bf16 v[0:3], a[160:163], v[144:147], v[0:3]
    v_mfma_f32_16x16x32_bf16 v[4:7], a[164:167], v[144:147], v[4:7]
    v_exp_f32 v137, v137
    v_mfma_f32_16x16x32_bf16 v[8:11], a[168:171], v[144:147], v[8:11]
    ds_read_b128 a[72:75], v172 offset:2048
    v_cvt_pk_bf16_f32 v148, v136, v137
    v_mfma_f32_16x16x32_bf16 v[12:15], a[172:175], v[144:147], v[12:15]
    v_exp_f32 v138, v138
    v_mfma_f32_16x16x32_bf16 v[16:19], a[176:179], v[144:147], v[16:19]
    v_mfma_f32_16x16x32_bf16 v[20:23], a[180:183], v[144:147], v[20:23]
    v_exp_f32 v139, v139
    v_mfma_f32_16x16x32_bf16 v[24:27], a[184:187], v[144:147], v[24:27]
    ds_read_b128 a[76:79], v172 offset:3072
    v_cvt_pk_bf16_f32 v149, v138, v139
    v_mfma_f32_16x16x32_bf16 v[28:31], a[188:191], v[144:147], v[28:31]
    v_exp_f32 v140, v140
    v_mfma_f32_16x16x32_bf16 v[152:155], v[168:171], v[144:147], v[152:155]
    v_mfma_f32_16x16x32_bf16 v[128:131], a[96:99], a[32:35], 0
    v_exp_f32 v141, v141
    v_mfma_f32_16x16x32_bf16 v[128:131], a[100:103], a[36:39], v[128:131]
    ds_read_b128 a[80:83], v172 offset:4096
    v_cvt_pk_bf16_f32 v150, v140, v141
    v_mfma_f32_16x16x32_bf16 v[128:131], a[104:107], a[40:43], v[128:131]
    v_exp_f32 v142, v142
    v_mfma_f32_16x16x32_bf16 v[128:131], a[108:111], a[44:47], v[128:131]
    v_mfma_f32_16x16x32_bf16 v[132:135], a[112:115], a[32:35], 0
    v_exp_f32 v143, v143
    v_mfma_f32_16x16x32_bf16 v[132:135], a[116:119], a[36:39], v[132:135]
    ds_read_b128 a[84:87], v172 offset:5120
    v_cvt_pk_bf16_f32 v151, v142, v143
    v_mfma_f32_16x16x32_bf16 v[132:135], a[120:123], a[40:43], v[132:135]
    v_mfma_f32_16x16x32_bf16 v[132:135], a[124:127], a[44:47], v[132:135]
    v_exp_f32 v128, v128
    v_mfma_f32_16x16x32_bf16 v[32:35], a[160:163], v[148:151], v[32:35]
    v_mfma_f32_16x16x32_bf16 v[36:39], a[164:167], v[148:151], v[36:39]
    v_exp_f32 v129, v129
    v_mfma_f32_16x16x32_bf16 v[40:43], a[168:171], v[148:151], v[40:43]
    ds_read_b128 a[88:91], v172 offset:6144
    v_cvt_pk_bf16_f32 v144, v128, v129
    v_mfma_f32_16x16x32_bf16 v[44:47], a[172:175], v[148:151], v[44:47]
    v_exp_f32 v130, v130
    v_mfma_f32_16x16x32_bf16 v[48:51], a[176:179], v[148:151], v[48:51]
    v_mfma_f32_16x16x32_bf16 v[52:55], a[180:183], v[148:151], v[52:55]
    v_exp_f32 v131, v131
    v_mfma_f32_16x16x32_bf16 v[56:59], a[184:187], v[148:151], v[56:59]
    ds_read_b128 a[92:95], v172 offset:7168
    v_cvt_pk_bf16_f32 v145, v130, v131
    v_mfma_f32_16x16x32_bf16 v[60:63], a[188:191], v[148:151], v[60:63]
    v_exp_f32 v132, v132
    v_mfma_f32_16x16x32_bf16 v[156:159], v[168:171], v[148:151], v[156:159]
    v_mfma_f32_16x16x32_bf16 v[136:139], a[96:99], a[48:51], 0
    v_exp_f32 v133, v133
    v_mfma_f32_16x16x32_bf16 v[136:139], a[100:103], a[52:55], v[136:139]
    ds_read_b128 a[128:131], v172 offset:8192
    v_cvt_pk_bf16_f32 v146, v132, v133
    v_mfma_f32_16x16x32_bf16 v[136:139], a[104:107], a[56:59], v[136:139]
    v_exp_f32 v134, v134
    v_mfma_f32_16x16x32_bf16 v[136:139], a[108:111], a[60:63], v[136:139]
    v_mfma_f32_16x16x32_bf16 v[140:143], a[112:115], a[48:51], 0
    v_exp_f32 v135, v135
    v_mfma_f32_16x16x32_bf16 v[140:143], a[116:119], a[52:55], v[140:143]
    ds_read_b128 a[132:135], v172 offset:9216
    v_cvt_pk_bf16_f32 v147, v134, v135
    v_mfma_f32_16x16x32_bf16 v[140:143], a[120:123], a[56:59], v[140:143]
    v_mfma_f32_16x16x32_bf16 v[140:143], a[124:127], a[60:63], v[140:143]
    v_exp_f32 v136, v136
    v_mfma_f32_16x16x32_bf16 v[64:67], a[160:163], v[144:147], v[64:67]
    v_mfma_f32_16x16x32_bf16 v[68:71], a[164:167], v[144:147], v[68:71]
    v_exp_f32 v137, v137
    v_mfma_f32_16x16x32_bf16 v[72:75], a[168:171], v[144:147], v[72:75]
    ds_read_b128 a[136:139], v172 offset:10240
    v_cvt_pk_bf16_f32 v148, v136, v137
    v_mfma_f32_16x16x32_bf16 v[76:79], a[172:175], v[144:147], v[76:79]
    v_exp_f32 v138, v138
    v_mfma_f32_16x16x32_bf16 v[80:83], a[176:179], v[144:147], v[80:83]
    v_mfma_f32_16x16x32_bf16 v[84:87], a[180:183], v[144:147], v[84:87]
    v_exp_f32 v139, v139
    v_mfma_f32_16x16x32_bf16 v[88:91], a[184:187], v[144:147], v[88:91]
    ds_read_b128 a[140:143], v172 offset:11264
    v_cvt_pk_bf16_f32 v149, v138, v139
    v_mfma_f32_16x16x32_bf16 v[92:95], a[188:191], v[144:147], v[92:95]
    v_exp_f32 v140, v140
    v_mfma_f32_16x16x32_bf16 v[160:163], v[168:171], v[144:147], v[160:163]
    v_xor_b32 v173, 0x10000, v173
    s_sub_u32 s30, s30, 1
.p2align 6
L_loop:
    s_waitcnt lgkmcnt(1)
    v_mfma_f32_16x16x32_bf16 v[128:131], a[64:67], a[0:3], 0
    v_exp_f32 v141, v141
    v_mfma_f32_16x16x32_bf16 v[128:131], a[68:71], a[4:7], v[128:131]
    ds_read_b128 a[144:147], v173 offset:12288
    v_cvt_pk_bf16_f32 v150, v140, v141
    v_mfma_f32_16x16x32_bf16 v[128:131], a[72:75], a[8:11], v[128:131]
    v_exp_f32 v142, v142
    v_mfma_f32_16x16x32_bf16 v[128:131], a[76:79], a[12:15], v[128:131]
    ds_read_b128 a[148:151], v173 offset:13312
    v_mfma_f32_16x16x32_bf16 v[132:135], a[80:83], a[0:3], 0
    v_exp_f32 v143, v143
    v_mfma_f32_16x16x32_bf16 v[132:135], a[84:87], a[4:7], v[132:135]
    ds_read_b128 a[152:155], v173 offset:14336
    v_cvt_pk_bf16_f32 v151, v142, v143
    v_mfma_f32_16x16x32_bf16 v[132:135], a[88:91], a[8:11], v[132:135]
    global_load_lds_dwordx4 v176, s[24:25] sc1
    v_mfma_f32_16x16x32_bf16 v[132:135], a[92:95], a[12:15], v[132:135]
    v_exp_f32 v128, v128
    v_mfma_f32_16x16x32_bf16 v[96:99], a[160:163], v[148:151], v[96:99]
    ds_read_b128 a[156:159], v173 offset:15360
    v_mfma_f32_16x16x32_bf16 v[100:103], a[164:167], v[148:151], v[100:103]
    v_exp_f32 v129, v129
    v_mfma_f32_16x16x32_bf16 v[104:107], a[168:171], v[148:151], v[104:107]
    v_cvt_pk_bf16_f32 v144, v128, v129
    v_mfma_f32_16x16x32_bf16 v[108:111], a[172:175], v[148:151], v[108:111]
    v_exp_f32 v130, v130
    v_mfma_f32_16x16x32_bf16 v[112:115], a[176:179], v[148:151], v[112:115]
    global_load_lds_dwordx4 v176, s[24:25] offset:1024 sc1
    v_mfma_f32_16x16x32_bf16 v[116:119], a[180:183], v[148:151], v[116:119]
    v_exp_f32 v131, v131
    v_mfma_f32_16x16x32_bf16 v[120:123], a[184:187], v[148:151], v[120:123]
    v_cvt_pk_bf16_f32 v145, v130, v131
    v_mfma_f32_16x16x32_bf16 v[124:127], a[188:191], v[148:151], v[124:127]
    v_exp_f32 v132, v132
    v_mfma_f32_16x16x32_bf16 v[164:167], v[168:171], v[148:151], v[164:167]
    global_load_lds_dwordx4 v176, s[24:25] offset:2048 sc1
    v_mfma_f32_16x16x32_bf16 v[136:139], a[64:67], a[16:19], 0
    v_exp_f32 v133, v133
    v_mfma_f32_16x16x32_bf16 v[136:139], a[68:71], a[20:23], v[136:139]
    ds_read_b128 a[96:99], v172 offset:16384
    v_cvt_pk_bf16_f32 v146, v132, v133
    v_mfma_f32_16x16x32_bf16 v[136:139], a[72:75], a[24:27], v[136:139]
    v_exp_f32 v134, v134
    v_mfma_f32_16x16x32_bf16 v[136:139], a[76:79], a[28:31], v[136:139]
    global_load_lds_dwordx4 v176, s[24:25] offset:3072 sc1
    v_mfma_f32_16x16x32_bf16 v[140:143], a[80:83], a[16:19], 0
    v_exp_f32 v135, v135
    v_mfma_f32_16x16x32_bf16 v[140:143], a[84:87], a[20:23], v[140:143]
    ds_read_b128 a[100:103], v172 offset:17408
    v_cvt_pk_bf16_f32 v147, v134, v135
    s_add_u32 m0, m0, 0x1000
    v_mfma_f32_16x16x32_bf16 v[140:143], a[88:91], a[24:27], v[140:143]
    global_load_lds_dwordx4 v177, s[24:25] sc1
    v_mfma_f32_16x16x32_bf16 v[140:143], a[92:95], a[28:31], v[140:143]
    v_exp_f32 v136, v136
    v_mfma_f32_16x16x32_bf16 v[0:3], a[128:131], v[144:147], v[0:3]
    v_mfma_f32_16x16x32_bf16 v[4:7], a[132:135], v[144:147], v[4:7]
    v_exp_f32 v137, v137
    v_mfma_f32_16x16x32_bf16 v[8:11], a[136:139], v[144:147], v[8:11]
    ds_read_b128 a[104:107], v172 offset:18432
    v_cvt_pk_bf16_f32 v148, v136, v137
    s_waitcnt lgkmcnt(2)
    v_mfma_f32_16x16x32_bf16 v[12:15], a[140:143], v[144:147], v[12:15]
    v_exp_f32 v138, v138
    v_mfma_f32_16x16x32_bf16 v[16:19], a[144:147], v[144:147], v[16:19]
    global_load_lds_dwordx4 v177, s[24:25] offset:1024 sc1
    v_mfma_f32_16x16x32_bf16 v[20:23], a[148:151], v[144:147], v[20:23]
    v_exp_f32 v139, v139
    v_mfma_f32_16x16x32_bf16 v[24:27], a[152:155], v[144:147], v[24:27]
    ds_read_b128 a[108:111], v172 offset:19456
    v_cvt_pk_bf16_f32 v149, v138, v139
    v_mfma_f32_16x16x32_bf16 v[28:31], a[156:159], v[144:147], v[28:31]
    v_exp_f32 v140, v140
    v_mfma_f32_16x16x32_bf16 v[152:155], v[168:171], v[144:147], v[152:155]
    global_load_lds_dwordx4 v177, s[24:25] offset:2048 sc1
    v_mfma_f32_16x16x32_bf16 v[128:131], a[64:67], a[32:35], 0
    v_exp_f32 v141, v141
    v_mfma_f32_16x16x32_bf16 v[128:131], a[68:71], a[36:39], v[128:131]
    ds_read_b128 a[112:115], v172 offset:20480
    v_cvt_pk_bf16_f32 v150, v140, v141
    v_mfma_f32_16x16x32_bf16 v[128:131], a[72:75], a[40:43], v[128:131]
    v_exp_f32 v142, v142
    v_mfma_f32_16x16x32_bf16 v[128:131], a[76:79], a[44:47], v[128:131]
    global_load_lds_dwordx4 v177, s[24:25] offset:3072 sc1
    v_mfma_f32_16x16x32_bf16 v[132:135], a[80:83], a[32:35], 0
    v_exp_f32 v143, v143
    v_mfma_f32_16x16x32_bf16 v[132:135], a[84:87], a[36:39], v[132:135]
    ds_read_b128 a[116:119], v172 offset:21504
    v_cvt_pk_bf16_f32 v151, v142, v143
    s_add_u32 m0, m0, 0x1000
    v_mfma_f32_16x16x32_bf16 v[132:135], a[88:91], a[40:43], v[132:135]
    global_load_lds_dwordx4 v178, s[24:25] sc1
    v_mfma_f32_16x16x32_bf16 v[132:135], a[92:95], a[44:47], v[132:135]
    v_exp_f32 v128, v128
    v_mfma_f32_16x16x32_bf16 v[32:35], a[128:131], v[148:151], v[32:35]
    v_mfma_f32_16x16x32_bf16 v[36:39], a[132:135], v[148:151], v[36:39]
    v_exp_f32 v129, v129
    v_mfma_f32_16x16x32_bf16 v[40:43], a[136:139], v[148:151], v[40:43]
    ds_read_b128 a[120:123], v172 offset:22528
    v_cvt_pk_bf16_f32 v144, v128, v129
    v_mfma_f32_16x16x32_bf16 v[44:47], a[140:143], v[148:151], v[44:47]
    v_exp_f32 v130, v130
    v_mfma_f32_16x16x32_bf16 v[48:51], a[144:147], v[148:151], v[48:51]
    global_load_lds_dwordx4 v178, s[24:25] offset:1024 sc1
    v_mfma_f32_16x16x32_bf16 v[52:55], a[148:151], v[148:151], v[52:55]
    v_exp_f32 v131, v131
    v_mfma_f32_16x16x32_bf16 v[56:59], a[152:155], v[148:151], v[56:59]
    ds_read_b128 a[124:127], v172 offset:23552
    v_cvt_pk_bf16_f32 v145, v130, v131
    v_mfma_f32_16x16x32_bf16 v[60:63], a[156:159], v[148:151], v[60:63]
    v_exp_f32 v132, v132
    v_mfma_f32_16x16x32_bf16 v[156:159], v[168:171], v[148:151], v[156:159]
    global_load_lds_dwordx4 v178, s[24:25] offset:2048 sc1
    v_mfma_f32_16x16x32_bf16 v[136:139], a[64:67], a[48:51], 0
    v_exp_f32 v133, v133
    v_mfma_f32_16x16x32_bf16 v[136:139], a[68:71], a[52:55], v[136:139]
    ds_read_b128 a[160:163], v172 offset:24576
    v_cvt_pk_bf16_f32 v146, v132, v133
    v_mfma_f32_16x16x32_bf16 v[136:139], a[72:75], a[56:59], v[136:139]
    v_exp_f32 v134, v134
    v_mfma_f32_16x16x32_bf16 v[136:139], a[76:79], a[60:63], v[136:139]
    global_load_lds_dwordx4 v178, s[24:25] offset:3072 sc1
    v_mfma_f32_16x16x32_bf16 v[140:143], a[80:83], a[48:51], 0
    v_exp_f32 v135, v135
    v_mfma_f32_16x16x32_bf16 v[140:143], a[84:87], a[52:55], v[140:143]
    ds_read_b128 a[164:167], v172 offset:25600
    v_cvt_pk_bf16_f32 v147, v134, v135
    s_add_u32 m0, m0, 0x1000
    v_mfma_f32_16x16x32_bf16 v[140:143], a[88:91], a[56:59], v[140:143]
    global_load_lds_dwordx4 v179, s[24:25] sc1
    v_mfma_f32_16x16x32_bf16 v[140:143], a[92:95], a[60:63], v[140:143]
    v_exp_f32 v136, v136
    v_mfma_f32_16x16x32_bf16 v[64:67], a[128:131], v[144:147], v[64:67]
    v_mfma_f32_16x16x32_bf16 v[68:71], a[132:135], v[144:147], v[68:71]
    v_exp_f32 v137, v137
    v_mfma_f32_16x16x32_bf16 v[72:75], a[136:139], v[144:147], v[72:75]
    ds_read_b128 a[168:171], v172 offset:26624
    v_cvt_pk_bf16_f32 v148, v136, v137
    v_mfma_f32_16x16x32_bf16 v[76:79], a[140:143], v[144:147], v[76:79]
    v_exp_f32 v138, v138
    v_mfma_f32_16x16x32_bf16 v[80:83], a[144:147], v[144:147], v[80:83]
    global_load_lds_dwordx4 v179, s[24:25] offset:1024 sc1
    v_mfma_f32_16x16x32_bf16 v[84:87], a[148:151], v[144:147], v[84:87]
    v_exp_f32 v139, v139
    v_mfma_f32_16x16x32_bf16 v[88:91], a[152:155], v[144:147], v[88:91]
    ds_read_b128 a[172:175], v172 offset:27648
    v_cvt_pk_bf16_f32 v149, v138, v139
    v_mfma_f32_16x16x32_bf16 v[92:95], a[156:159], v[144:147], v[92:95]
    v_exp_f32 v140, v140
    v_mfma_f32_16x16x32_bf16 v[160:163], v[168:171], v[144:147], v[160:163]
    global_load_lds_dwordx4 v179, s[24:25] offset:2048 sc1
    v_mfma_f32_16x16x32_bf16 v[128:131], a[96:99], a[0:3], 0
    v_exp_f32 v141, v141
    s_waitcnt lgkmcnt(1)
    v_mfma_f32_16x16x32_bf16 v[128:131], a[100:103], a[4:7], v[128:131]
    ds_read_b128 a[176:179], v173 offset:28672
    v_cvt_pk_bf16_f32 v150, v140, v141
    v_mfma_f32_16x16x32_bf16 v[128:131], a[104:107], a[8:11], v[128:131]
    v_exp_f32 v142, v142
    v_mfma_f32_16x16x32_bf16 v[128:131], a[108:111], a[12:15], v[128:131]
    ds_read_b128 a[180:183], v173 offset:29696
    v_mfma_f32_16x16x32_bf16 v[132:135], a[112:115], a[0:3], 0
    v_exp_f32 v143, v143
    v_mfma_f32_16x16x32_bf16 v[132:135], a[116:119], a[4:7], v[132:135]
    ds_read_b128 a[184:187], v173 offset:30720
    v_cvt_pk_bf16_f32 v151, v142, v143
    v_mfma_f32_16x16x32_bf16 v[132:135], a[120:123], a[8:11], v[132:135]
    global_load_lds_dwordx4 v179, s[24:25] offset:3072 sc1
    v_mfma_f32_16x16x32_bf16 v[132:135], a[124:127], a[12:15], v[132:135]
    v_exp_f32 v128, v128
    s_add_u32 s24, s24, 0x10000
    s_addc_u32 s25, s25, 0
    v_mfma_f32_16x16x32_bf16 v[96:99], a[128:131], v[148:151], v[96:99]
    ds_read_b128 a[188:191], v173 offset:31744
    v_mfma_f32_16x16x32_bf16 v[100:103], a[132:135], v[148:151], v[100:103]
    v_exp_f32 v129, v129
    v_mfma_f32_16x16x32_bf16 v[104:107], a[136:139], v[148:151], v[104:107]
    v_cvt_pk_bf16_f32 v144, v128, v129
    v_mfma_f32_16x16x32_bf16 v[108:111], a[140:143], v[148:151], v[108:111]
    v_exp_f32 v130, v130
    v_mfma_f32_16x16x32_bf16 v[112:115], a[144:147], v[148:151], v[112:115]
    buffer_load_dwordx2 v[234:235], v237, s[60:63], 0 offen sc1
    v_mfma_f32_16x16x32_bf16 v[116:119], a[148:151], v[148:151], v[116:119]
    v_exp_f32 v131, v131
    v_mfma_f32_16x16x32_bf16 v[120:123], a[152:155], v[148:151], v[120:123]
    ds_read_b128 v[196:199], v228
    v_cvt_pk_bf16_f32 v145, v130, v131
    v_mfma_f32_16x16x32_bf16 v[124:127], a[156:159], v[148:151], v[124:127]
    v_exp_f32 v132, v132
    v_mfma_f32_16x16x32_bf16 v[164:167], v[168:171], v[148:151], v[164:167]
    ds_read_b128 v[204:207], v228 offset:256
    v_mfma_f32_16x16x32_bf16 v[136:139], a[96:99], a[16:19], 0
    v_exp_f32 v133, v133
    v_mfma_f32_16x16x32_bf16 v[136:139], a[100:103], a[20:23], v[136:139]
    ds_read_b128 a[64:67], v172 offset:32768
    v_cvt_pk_bf16_f32 v146, v132, v133
    v_mfma_f32_16x16x32_bf16 v[136:139], a[104:107], a[24:27], v[136:139]
    v_exp_f32 v134, v134
    v_mfma_f32_16x16x32_bf16 v[136:139], a[108:111], a[28:31], v[136:139]
    ds_read_b128 v[200:203], v228 offset:16
    v_mfma_f32_16x16x32_bf16 v[140:143], a[112:115], a[16:19], 0
    v_exp_f32 v135, v135
    v_mfma_f32_16x16x32_bf16 v[140:143], a[116:119], a[20:23], v[140:143]
    ds_read_b128 a[68:71], v172 offset:33792
    v_cvt_pk_bf16_f32 v147, v134, v135
    v_mfma_f32_16x16x32_bf16 v[140:143], a[120:123], a[24:27], v[140:143]
    ds_read_b128 v[208:211], v228 offset:272
    v_mfma_f32_16x16x32_bf16 v[140:143], a[124:127], a[28:31], v[140:143]
    v_exp_f32 v136, v136
    v_mfma_f32_16x16x32_bf16 v[0:3], a[160:163], v[144:147], v[0:3]
    ds_read_b64 v[212:213], v229
    v_mfma_f32_16x16x32_bf16 v[4:7], a[164:167], v[144:147], v[4:7]
    v_exp_f32 v137, v137
    v_mfma_f32_16x16x32_bf16 v[8:11], a[168:171], v[144:147], v[8:11]
    ds_read_b128 a[72:75], v172 offset:34816
    v_cvt_pk_bf16_f32 v148, v136, v137
    s_waitcnt lgkmcnt(4)
    v_mfma_f32_16x16x32_bf16 v[12:15], a[172:175], v[144:147], v[12:15]
    v_exp_f32 v138, v138
    v_mfma_f32_16x16x32_bf16 v[16:19], a[176:179], v[144:147], v[16:19]
    s_waitcnt vmcnt(23)
    v_cvt_f32_i32 v240, v180
    v_cvt_f32_i32 v241, v181
    v_mfma_f32_16x16x32_bf16 v[20:23], a[180:183], v[144:147], v[20:23]
    v_exp_f32 v139, v139
    v_mfma_f32_16x16x32_bf16 v[24:27], a[184:187], v[144:147], v[24:27]
    ds_read_b128 a[76:79], v172 offset:35840
    v_cvt_pk_bf16_f32 v149, v138, v139
    v_mfma_f32_16x16x32_bf16 v[28:31], a[188:191], v[144:147], v[28:31]
    v_exp_f32 v140, v140
    v_mfma_f32_16x16x32_bf16 v[152:155], v[168:171], v[144:147], v[152:155]
    v_cvt_f32_i32 v242, v182
    v_cvt_f32_i32 v243, v183
    v_mfma_f32_16x16x32_bf16 v[128:131], a[96:99], a[32:35], 0
    v_exp_f32 v141, v141
    v_mfma_f32_16x16x32_bf16 v[128:131], a[100:103], a[36:39], v[128:131]
    ds_read_b128 a[80:83], v172 offset:36864
    v_cvt_pk_bf16_f32 v150, v140, v141
    v_mfma_f32_16x16x32_bf16 v[128:131], a[104:107], a[40:43], v[128:131]
    v_exp_f32 v142, v142
    v_mfma_f32_16x16x32_bf16 v[128:131], a[108:111], a[44:47], v[128:131]
    s_waitcnt vmcnt(22)
    v_cvt_f32_i32 v244, v184
    v_cvt_f32_i32 v245, v185
    v_mfma_f32_16x16x32_bf16 v[132:135], a[112:115], a[32:35], 0
    v_exp_f32 v143, v143
    v_mfma_f32_16x16x32_bf16 v[132:135], a[116:119], a[36:39], v[132:135]
    ds_read_b128 a[84:87], v172 offset:37888
    v_cvt_pk_bf16_f32 v151, v142, v143
    v_mfma_f32_16x16x32_bf16 v[132:135], a[120:123], a[40:43], v[132:135]
    v_cvt_f32_i32 v246, v186
    v_cvt_f32_i32 v247, v187
    v_mfma_f32_16x16x32_bf16 v[132:135], a[124:127], a[44:47], v[132:135]
    v_exp_f32 v128, v128
    v_mfma_f32_16x16x32_bf16 v[32:35], a[160:163], v[148:151], v[32:35]
    buffer_load_dwordx4 v[180:183], v226, s[12:15], s31 offen
    v_mfma_f32_16x16x32_bf16 v[36:39], a[164:167], v[148:151], v[36:39]
    v_exp_f32 v129, v129
    v_mfma_f32_16x16x32_bf16 v[40:43], a[168:171], v[148:151], v[40:43]
    ds_read_b128 a[88:91], v172 offset:38912
    v_cvt_pk_bf16_f32 v144, v128, v129
    v_mfma_f32_16x16x32_bf16 v[44:47], a[172:175], v[148:151], v[44:47]
    v_exp_f32 v130, v130
    v_mfma_f32_16x16x32_bf16 v[48:51], a[176:179], v[148:151], v[48:51]
    buffer_load_dwordx4 v[184:187], v226, s[12:15], s31 offen offset:16
    v_mfma_f32_16x16x32_bf16 v[52:55], a[180:183], v[148:151], v[52:55]
    v_exp_f32 v131, v131
    v_mfma_f32_16x16x32_bf16 v[56:59], a[184:187], v[148:151], v[56:59]
    ds_read_b128 a[92:95], v172 offset:39936
    v_cvt_pk_bf16_f32 v145, v130, v131
    v_mfma_f32_16x16x32_bf16 v[60:63], a[188:191], v[148:151], v[60:63]
    v_exp_f32 v132, v132
    v_mfma_f32_16x16x32_bf16 v[156:159], v[168:171], v[148:151], v[156:159]
    s_waitcnt vmcnt(23)
    v_cvt_f32_i32 v248, v188
    v_cvt_f32_i32 v249, v189
    v_mfma_f32_16x16x32_bf16 v[136:139], a[96:99], a[48:51], 0
    v_exp_f32 v133, v133
    v_mfma_f32_16x16x32_bf16 v[136:139], a[100:103], a[52:55], v[136:139]
    ds_read_b128 a[128:131], v172 offset:40960
    v_cvt_pk_bf16_f32 v146, v132, v133
    v_mfma_f32_16x16x32_bf16 v[136:139], a[104:107], a[56:59], v[136:139]
    v_exp_f32 v134, v134
    v_mfma_f32_16x16x32_bf16 v[136:139], a[108:111], a[60:63], v[136:139]
    v_cvt_f32_i32 v250, v190
    v_cvt_f32_i32 v251, v191
    v_mfma_f32_16x16x32_bf16 v[140:143], a[112:115], a[48:51], 0
    v_exp_f32 v135, v135
    v_mfma_f32_16x16x32_bf16 v[140:143], a[116:119], a[52:55], v[140:143]
    ds_read_b128 a[132:135], v172 offset:41984
    v_cvt_pk_bf16_f32 v147, v134, v135
    v_mfma_f32_16x16x32_bf16 v[140:143], a[120:123], a[56:59], v[140:143]
    s_waitcnt vmcnt(22)
    v_cvt_f32_i32 v252, v192
    v_cvt_f32_i32 v253, v193
    v_mfma_f32_16x16x32_bf16 v[140:143], a[124:127], a[60:63], v[140:143]
    v_exp_f32 v136, v136
    v_mfma_f32_16x16x32_bf16 v[64:67], a[160:163], v[144:147], v[64:67]
    v_cvt_f32_i32 v254, v194
    v_cvt_f32_i32 v255, v195
    v_mfma_f32_16x16x32_bf16 v[68:71], a[164:167], v[144:147], v[68:71]
    v_exp_f32 v137, v137
    v_mfma_f32_16x16x32_bf16 v[72:75], a[168:171], v[144:147], v[72:75]
    ds_read_b128 a[136:139], v172 offset:43008
    v_cvt_pk_bf16_f32 v148, v136, v137
    v_mfma_f32_16x16x32_bf16 v[76:79], a[172:175], v[144:147], v[76:79]
    v_exp_f32 v138, v138
    v_mfma_f32_16x16x32_bf16 v[80:83], a[176:179], v[144:147], v[80:83]
    buffer_load_dwordx4 v[188:191], v227, s[16:19], s31 offen
    v_mfma_f32_16x16x32_bf16 v[84:87], a[180:183], v[144:147], v[84:87]
    v_exp_f32 v139, v139
    v_mfma_f32_16x16x32_bf16 v[88:91], a[184:187], v[144:147], v[88:91]
    ds_read_b128 a[140:143], v172 offset:44032
    v_cvt_pk_bf16_f32 v149, v138, v139
    v_mfma_f32_16x16x32_bf16 v[92:95], a[188:191], v[144:147], v[92:95]
    v_exp_f32 v140, v140
    v_mfma_f32_16x16x32_bf16 v[160:163], v[168:171], v[144:147], v[160:163]
    buffer_load_dwordx4 v[192:195], v227, s[16:19], s31 offen offset:16
    v_mfma_f32_16x16x32_bf16 v[128:131], a[64:67], a[0:3], 0
    v_exp_f32 v141, v141
    s_add_u32 s31, s31, 0x10000
    s_waitcnt lgkmcnt(1)
    v_mfma_f32_16x16x32_bf16 v[128:131], a[68:71], a[4:7], v[128:131]
    ds_read_b128 a[144:147], v173 offset:45056
    v_cvt_pk_bf16_f32 v150, v140, v141
    v_mfma_f32_16x16x32_bf16 v[128:131], a[72:75], a[8:11], v[128:131]
    v_exp_f32 v142, v142
    v_mfma_f32_16x16x32_bf16 v[128:131], a[76:79], a[12:15], v[128:131]
    ds_read_b128 a[148:151], v173 offset:46080
    v_fma_f32 v240, v240, v196, v204
    v_mfma_f32_16x16x32_bf16 v[132:135], a[80:83], a[0:3], 0
    v_exp_f32 v143, v143
    v_mfma_f32_16x16x32_bf16 v[132:135], a[84:87], a[4:7], v[132:135]
    ds_read_b128 a[152:155], v173 offset:47104
    v_cvt_pk_bf16_f32 v151, v142, v143
    v_mfma_f32_16x16x32_bf16 v[132:135], a[88:91], a[8:11], v[132:135]
    v_fma_f32 v241, v241, v197, v205
    v_fma_f32 v242, v242, v198, v206
    v_mfma_f32_16x16x32_bf16 v[132:135], a[92:95], a[12:15], v[132:135]
    v_exp_f32 v128, v128
    v_mfma_f32_16x16x32_bf16 v[96:99], a[160:163], v[148:151], v[96:99]
    ds_read_b128 a[156:159], v173 offset:48128
    v_fma_f32 v243, v243, v199, v207
    v_mfma_f32_16x16x32_bf16 v[100:103], a[164:167], v[148:151], v[100:103]
    v_exp_f32 v129, v129
    v_mfma_f32_16x16x32_bf16 v[104:107], a[168:171], v[148:151], v[104:107]
    v_cvt_pk_bf16_f32 v144, v128, v129
    v_fma_f32 v244, v244, v200, v208
    v_mfma_f32_16x16x32_bf16 v[108:111], a[172:175], v[148:151], v[108:111]
    v_exp_f32 v130, v130
    v_mfma_f32_16x16x32_bf16 v[112:115], a[176:179], v[148:151], v[112:115]
    v_fma_f32 v245, v245, v201, v209
    v_fma_f32 v246, v246, v202, v210
    v_mfma_f32_16x16x32_bf16 v[116:119], a[180:183], v[148:151], v[116:119]
    v_exp_f32 v131, v131
    v_mfma_f32_16x16x32_bf16 v[120:123], a[184:187], v[148:151], v[120:123]
    v_cvt_pk_bf16_f32 v145, v130, v131
    v_fma_f32 v247, v247, v203, v211
    v_mfma_f32_16x16x32_bf16 v[124:127], a[188:191], v[148:151], v[124:127]
    v_exp_f32 v132, v132
    v_mfma_f32_16x16x32_bf16 v[164:167], v[168:171], v[148:151], v[164:167]
    v_cvt_pk_bf16_f32 v214, v240, v241
    v_cvt_pk_bf16_f32 v215, v242, v243
    v_mfma_f32_16x16x32_bf16 v[136:139], a[64:67], a[16:19], 0
    v_exp_f32 v133, v133
    v_mfma_f32_16x16x32_bf16 v[136:139], a[68:71], a[20:23], v[136:139]
    ds_read_b128 a[96:99], v172 offset:49152
    v_cvt_pk_bf16_f32 v146, v132, v133
    v_mfma_f32_16x16x32_bf16 v[136:139], a[72:75], a[24:27], v[136:139]
    v_exp_f32 v134, v134
    v_mfma_f32_16x16x32_bf16 v[136:139], a[76:79], a[28:31], v[136:139]
    v_cvt_pk_bf16_f32 v216, v244, v245
    v_cvt_pk_bf16_f32 v217, v246, v247
    v_mfma_f32_16x16x32_bf16 v[140:143], a[80:83], a[16:19], 0
    v_exp_f32 v135, v135
    v_mfma_f32_16x16x32_bf16 v[140:143], a[84:87], a[20:23], v[140:143]
    ds_read_b128 a[100:103], v172 offset:50176
    v_cvt_pk_bf16_f32 v147, v134, v135
    v_mfma_f32_16x16x32_bf16 v[140:143], a[88:91], a[24:27], v[140:143]
    v_fma_f32 v248, v248, v212, v213
    v_fma_f32 v249, v249, v212, v213
    v_mfma_f32_16x16x32_bf16 v[140:143], a[92:95], a[28:31], v[140:143]
    v_exp_f32 v136, v136
    v_mfma_f32_16x16x32_bf16 v[0:3], a[128:131], v[144:147], v[0:3]
    v_fma_f32 v250, v250, v212, v213
    v_fma_f32 v251, v251, v212, v213
    v_mfma_f32_16x16x32_bf16 v[4:7], a[132:135], v[144:147], v[4:7]
    v_exp_f32 v137, v137
    v_mfma_f32_16x16x32_bf16 v[8:11], a[136:139], v[144:147], v[8:11]
    ds_read_b128 a[104:107], v172 offset:51200
    v_cvt_pk_bf16_f32 v148, v136, v137
    s_waitcnt lgkmcnt(2)
    v_mfma_f32_16x16x32_bf16 v[12:15], a[140:143], v[144:147], v[12:15]
    v_exp_f32 v138, v138
    v_mfma_f32_16x16x32_bf16 v[16:19], a[144:147], v[144:147], v[16:19]
    v_fma_f32 v252, v252, v212, v213
    v_fma_f32 v253, v253, v212, v213
    v_mfma_f32_16x16x32_bf16 v[20:23], a[148:151], v[144:147], v[20:23]
    v_exp_f32 v139, v139
    v_mfma_f32_16x16x32_bf16 v[24:27], a[152:155], v[144:147], v[24:27]
    ds_read_b128 a[108:111], v172 offset:52224
    v_cvt_pk_bf16_f32 v149, v138, v139
    v_mfma_f32_16x16x32_bf16 v[28:31], a[156:159], v[144:147], v[28:31]
    v_exp_f32 v140, v140
    v_mfma_f32_16x16x32_bf16 v[152:155], v[168:171], v[144:147], v[152:155]
    v_fma_f32 v254, v254, v212, v213
    v_fma_f32 v255, v255, v212, v213
    v_mfma_f32_16x16x32_bf16 v[128:131], a[64:67], a[32:35], 0
    v_exp_f32 v141, v141
    v_mfma_f32_16x16x32_bf16 v[128:131], a[68:71], a[36:39], v[128:131]
    ds_read_b128 a[112:115], v172 offset:53248
    v_cvt_pk_bf16_f32 v150, v140, v141
    v_mfma_f32_16x16x32_bf16 v[128:131], a[72:75], a[40:43], v[128:131]
    v_exp_f32 v142, v142
    v_mfma_f32_16x16x32_bf16 v[128:131], a[76:79], a[44:47], v[128:131]
    v_cvt_pk_bf16_f32 v218, v248, v249
    v_cvt_pk_bf16_f32 v219, v250, v251
    v_mfma_f32_16x16x32_bf16 v[132:135], a[80:83], a[32:35], 0
    v_exp_f32 v143, v143
    v_mfma_f32_16x16x32_bf16 v[132:135], a[84:87], a[36:39], v[132:135]
    ds_read_b128 a[116:119], v172 offset:54272
    v_cvt_pk_bf16_f32 v151, v142, v143
    v_mfma_f32_16x16x32_bf16 v[132:135], a[88:91], a[40:43], v[132:135]
    v_cvt_pk_bf16_f32 v220, v252, v253
    v_cvt_pk_bf16_f32 v221, v254, v255
    v_mfma_f32_16x16x32_bf16 v[132:135], a[92:95], a[44:47], v[132:135]
    v_exp_f32 v128, v128
    v_mfma_f32_16x16x32_bf16 v[32:35], a[128:131], v[148:151], v[32:35]
    ds_write_b128 v230, v[218:221]
    v_mfma_f32_16x16x32_bf16 v[36:39], a[132:135], v[148:151], v[36:39]
    v_exp_f32 v129, v129
    v_mfma_f32_16x16x32_bf16 v[40:43], a[136:139], v[148:151], v[40:43]
    ds_read_b128 a[120:123], v172 offset:55296
    v_cvt_pk_bf16_f32 v144, v128, v129
    v_mfma_f32_16x16x32_bf16 v[44:47], a[140:143], v[148:151], v[44:47]
    v_exp_f32 v130, v130
    v_mfma_f32_16x16x32_bf16 v[48:51], a[144:147], v[148:151], v[48:51]
    v_mfma_f32_16x16x32_bf16 v[52:55], a[148:151], v[148:151], v[52:55]
    v_exp_f32 v131, v131
    v_mfma_f32_16x16x32_bf16 v[56:59], a[152:155], v[148:151], v[56:59]
    ds_read_b128 a[124:127], v172 offset:56320
    v_cvt_pk_bf16_f32 v145, v130, v131
    v_mfma_f32_16x16x32_bf16 v[60:63], a[156:159], v[148:151], v[60:63]
    v_exp_f32 v132, v132
    v_mfma_f32_16x16x32_bf16 v[156:159], v[168:171], v[148:151], v[156:159]
    ds_read_b64_tr_b16 v[222:223], v231
    v_mfma_f32_16x16x32_bf16 v[136:139], a[64:67], a[48:51], 0
    v_exp_f32 v133, v133
    v_mfma_f32_16x16x32_bf16 v[136:139], a[68:71], a[52:55], v[136:139]
    ds_read_b128 a[160:163], v172 offset:57344
    v_cvt_pk_bf16_f32 v146, v132, v133
    v_mfma_f32_16x16x32_bf16 v[136:139], a[72:75], a[56:59], v[136:139]
    v_exp_f32 v134, v134
    v_mfma_f32_16x16x32_bf16 v[136:139], a[76:79], a[60:63], v[136:139]
    ds_read_b64_tr_b16 v[224:225], v231 offset:512
    v_mfma_f32_16x16x32_bf16 v[140:143], a[80:83], a[48:51], 0
    v_exp_f32 v135, v135
    v_mfma_f32_16x16x32_bf16 v[140:143], a[84:87], a[52:55], v[140:143]
    ds_read_b128 a[164:167], v172 offset:58368
    v_cvt_pk_bf16_f32 v147, v134, v135
    v_mfma_f32_16x16x32_bf16 v[140:143], a[88:91], a[56:59], v[140:143]
    buffer_store_dwordx4 v[214:217], v232, s[20:23], s32 offen sc1
    v_mfma_f32_16x16x32_bf16 v[140:143], a[92:95], a[60:63], v[140:143]
    v_exp_f32 v136, v136
    v_mfma_f32_16x16x32_bf16 v[64:67], a[128:131], v[144:147], v[64:67]
    v_mfma_f32_16x16x32_bf16 v[68:71], a[132:135], v[144:147], v[68:71]
    v_exp_f32 v137, v137
    v_mfma_f32_16x16x32_bf16 v[72:75], a[136:139], v[144:147], v[72:75]
    ds_read_b128 a[168:171], v172 offset:59392
    v_cvt_pk_bf16_f32 v148, v136, v137
    v_mfma_f32_16x16x32_bf16 v[76:79], a[140:143], v[144:147], v[76:79]
    v_exp_f32 v138, v138
    v_mfma_f32_16x16x32_bf16 v[80:83], a[144:147], v[144:147], v[80:83]
    s_waitcnt lgkmcnt(1)
    buffer_store_dwordx4 v[222:225], v233, s[20:23], s32 offen sc1
    v_mfma_f32_16x16x32_bf16 v[84:87], a[148:151], v[144:147], v[84:87]
    v_exp_f32 v139, v139
    v_mfma_f32_16x16x32_bf16 v[88:91], a[152:155], v[144:147], v[88:91]
    ds_read_b128 a[172:175], v172 offset:60416
    v_cvt_pk_bf16_f32 v149, v138, v139
    s_add_u32 s32, s32, 0x10000
    v_mfma_f32_16x16x32_bf16 v[92:95], a[156:159], v[144:147], v[92:95]
    v_exp_f32 v140, v140
    v_mfma_f32_16x16x32_bf16 v[160:163], v[168:171], v[144:147], v[160:163]
    v_add_u32 v228, 0x200, v228
    v_add_u32 v229, 0x100, v229
    v_mfma_f32_16x16x32_bf16 v[128:131], a[96:99], a[0:3], 0
    v_exp_f32 v141, v141
    v_mfma_f32_16x16x32_bf16 v[128:131], a[100:103], a[4:7], v[128:131]
    ds_read_b128 a[176:179], v173 offset:61440
    v_cvt_pk_bf16_f32 v150, v140, v141
    v_mfma_f32_16x16x32_bf16 v[128:131], a[104:107], a[8:11], v[128:131]
    v_exp_f32 v142, v142
    v_mfma_f32_16x16x32_bf16 v[128:131], a[108:111], a[12:15], v[128:131]
    ds_read_b128 a[180:183], v173 offset:62464
    v_mfma_f32_16x16x32_bf16 v[132:135], a[112:115], a[0:3], 0
    v_exp_f32 v143, v143
    v_mfma_f32_16x16x32_bf16 v[132:135], a[116:119], a[4:7], v[132:135]
    ds_read_b128 a[184:187], v173 offset:63488
    v_cvt_pk_bf16_f32 v151, v142, v143
    v_mfma_f32_16x16x32_bf16 v[132:135], a[120:123], a[8:11], v[132:135]
    v_mfma_f32_16x16x32_bf16 v[132:135], a[124:127], a[12:15], v[132:135]
    v_exp_f32 v128, v128
    v_mfma_f32_16x16x32_bf16 v[96:99], a[128:131], v[148:151], v[96:99]
    ds_read_b128 a[188:191], v173 offset:64512
    v_mfma_f32_16x16x32_bf16 v[100:103], a[132:135], v[148:151], v[100:103]
    v_exp_f32 v129, v129
    v_mfma_f32_16x16x32_bf16 v[104:107], a[136:139], v[148:151], v[104:107]
    v_cvt_pk_bf16_f32 v144, v128, v129
    v_mfma_f32_16x16x32_bf16 v[108:111], a[140:143], v[148:151], v[108:111]
    v_exp_f32 v130, v130
    v_mfma_f32_16x16x32_bf16 v[112:115], a[144:147], v[148:151], v[112:115]
    v_mfma_f32_16x16x32_bf16 v[116:119], a[148:151], v[148:151], v[116:119]
    v_exp_f32 v131, v131
    v_mfma_f32_16x16x32_bf16 v[120:123], a[152:155], v[148:151], v[120:123]
    v_cvt_pk_bf16_f32 v145, v130, v131
    v_mfma_f32_16x16x32_bf16 v[124:127], a[156:159], v[148:151], v[124:127]
    v_exp_f32 v132, v132
    v_mfma_f32_16x16x32_bf16 v[164:167], v[168:171], v[148:151], v[164:167]
    s_waitcnt vmcnt(6) lgkmcnt(0)
    s_barrier
    v_xor_b32 v172, 0x10000, v172
    s_xor_b32 s29, s29, 0x10000
    s_mov_b32 m0, s29
    v_readfirstlane_b32 s35, v234
    v_mfma_f32_16x16x32_bf16 v[136:139], a[96:99], a[16:19], 0
    v_readfirstlane_b32 s36, v235
    v_exp_f32 v133, v133
    v_mfma_f32_16x16x32_bf16 v[136:139], a[100:103], a[20:23], v[136:139]
    ds_read_b128 a[64:67], v172
    v_cvt_pk_bf16_f32 v146, v132, v133
    v_mfma_f32_16x16x32_bf16 v[136:139], a[104:107], a[24:27], v[136:139]
    v_exp_f32 v134, v134
    s_sub_u32 s35, s35, s33
    s_sub_u32 s36, s36, s33
    s_max_u32 s35, s35, s36
    s_cmp_ge_u32 s35, 32
    s_cbranch_scc1 L_spin_main
L_back_main:
    v_mfma_f32_16x16x32_bf16 v[136:139], a[108:111], a[28:31], v[136:139]
    v_mov_b32 v236, s34
    v_mfma_f32_16x16x32_bf16 v[140:143], a[112:115], a[16:19], 0
    v_exp_f32 v135, v135
    v_mfma_f32_16x16x32_bf16 v[140:143], a[116:119], a[20:23], v[140:143]
    ds_read_b128 a[68:71], v172 offset:1024
    v_cvt_pk_bf16_f32 v147, v134, v135
    v_mfma_f32_16x16x32_bf16 v[140:143], a[120:123], a[24:27], v[140:143]
    buffer_store_dword v236, v238, s[60:63], 0 offen sc1
    v_mfma_f32_16x16x32_bf16 v[140:143], a[124:127], a[28:31], v[140:143]
    v_exp_f32 v136, v136
    s_add_u32 s34, s34, 1
    s_add_u32 s33, s33, 1
    v_mfma_f32_16x16x32_bf16 v[0:3], a[160:163], v[144:147], v[0:3]
    v_mfma_f32_16x16x32_bf16 v[4:7], a[164:167], v[144:147], v[4:7]
    v_exp_f32 v137, v137
    v_mfma_f32_16x16x32_bf16 v[8:11], a[168:171], v[144:147], v[8:11]
    ds_read_b128 a[72:75], v172 offset:2048
    v_cvt_pk_bf16_f32 v148, v136, v137
    v_mfma_f32_16x16x32_bf16 v[12:15], a[172:175], v[144:147], v[12:15]
    v_exp_f32 v138, v138
    v_mfma_f32_16x16x32_bf16 v[16:19], a[176:179], v[144:147], v[16:19]
    v_mfma_f32_16x16x32_bf16 v[20:23], a[180:183], v[144:147], v[20:23]
    v_exp_f32 v139, v139
    v_mfma_f32_16x16x32_bf16 v[24:27], a[184:187], v[144:147], v[24:27]
    ds_read_b128 a[76:79], v172 offset:3072
    v_cvt_pk_bf16_f32 v149, v138, v139
    v_mfma_f32_16x16x32_bf16 v[28:31], a[188:191], v[144:147], v[28:31]
    v_exp_f32 v140, v140
    v_mfma_f32_16x16x32_bf16 v[152:155], v[168:171], v[144:147], v[152:155]
    v_mfma_f32_16x16x32_bf16 v[128:131], a[96:99], a[32:35], 0
    v_exp_f32 v141, v141
    v_mfma_f32_16x16x32_bf16 v[128:131], a[100:103], a[36:39], v[128:131]
    ds_read_b128 a[80:83], v172 offset:4096
    v_cvt_pk_bf16_f32 v150, v140, v141
    v_mfma_f32_16x16x32_bf16 v[128:131], a[104:107], a[40:43], v[128:131]
    v_exp_f32 v142, v142
    v_mfma_f32_16x16x32_bf16 v[128:131], a[108:111], a[44:47], v[128:131]
    v_mfma_f32_16x16x32_bf16 v[132:135], a[112:115], a[32:35], 0
    v_exp_f32 v143, v143
    v_mfma_f32_16x16x32_bf16 v[132:135], a[116:119], a[36:39], v[132:135]
    ds_read_b128 a[84:87], v172 offset:5120
    v_cvt_pk_bf16_f32 v151, v142, v143
    v_mfma_f32_16x16x32_bf16 v[132:135], a[120:123], a[40:43], v[132:135]
    v_mfma_f32_16x16x32_bf16 v[132:135], a[124:127], a[44:47], v[132:135]
    v_exp_f32 v128, v128
    v_mfma_f32_16x16x32_bf16 v[32:35], a[160:163], v[148:151], v[32:35]
    v_mfma_f32_16x16x32_bf16 v[36:39], a[164:167], v[148:151], v[36:39]
    v_exp_f32 v129, v129
    v_mfma_f32_16x16x32_bf16 v[40:43], a[168:171], v[148:151], v[40:43]
    ds_read_b128 a[88:91], v172 offset:6144
    v_cvt_pk_bf16_f32 v144, v128, v129
    v_mfma_f32_16x16x32_bf16 v[44:47], a[172:175], v[148:151], v[44:47]
    v_exp_f32 v130, v130
    v_mfma_f32_16x16x32_bf16 v[48:51], a[176:179], v[148:151], v[48:51]
    v_mfma_f32_16x16x32_bf16 v[52:55], a[180:183], v[148:151], v[52:55]
    v_exp_f32 v131, v131
    v_mfma_f32_16x16x32_bf16 v[56:59], a[184:187], v[148:151], v[56:59]
    ds_read_b128 a[92:95], v172 offset:7168
    v_cvt_pk_bf16_f32 v145, v130, v131
    v_mfma_f32_16x16x32_bf16 v[60:63], a[188:191], v[148:151], v[60:63]
    v_exp_f32 v132, v132
    v_mfma_f32_16x16x32_bf16 v[156:159], v[168:171], v[148:151], v[156:159]
    v_mfma_f32_16x16x32_bf16 v[136:139], a[96:99], a[48:51], 0
    v_exp_f32 v133, v133
    v_mfma_f32_16x16x32_bf16 v[136:139], a[100:103], a[52:55], v[136:139]
    ds_read_b128 a[128:131], v172 offset:8192
    v_cvt_pk_bf16_f32 v146, v132, v133
    v_mfma_f32_16x16x32_bf16 v[136:139], a[104:107], a[56:59], v[136:139]
    v_exp_f32 v134, v134
    v_mfma_f32_16x16x32_bf16 v[136:139], a[108:111], a[60:63], v[136:139]
    v_mfma_f32_16x16x32_bf16 v[140:143], a[112:115], a[48:51], 0
    v_exp_f32 v135, v135
    v_mfma_f32_16x16x32_bf16 v[140:143], a[116:119], a[52:55], v[140:143]
    ds_read_b128 a[132:135], v172 offset:9216
    v_cvt_pk_bf16_f32 v147, v134, v135
    v_mfma_f32_16x16x32_bf16 v[140:143], a[120:123], a[56:59], v[140:143]
    v_mfma_f32_16x16x32_bf16 v[140:143], a[124:127], a[60:63], v[140:143]
    v_exp_f32 v136, v136
    v_mfma_f32_16x16x32_bf16 v[64:67], a[160:163], v[144:147], v[64:67]
    v_mfma_f32_16x16x32_bf16 v[68:71], a[164:167], v[144:147], v[68:71]
    v_exp_f32 v137, v137
    v_mfma_f32_16x16x32_bf16 v[72:75], a[168:171], v[144:147], v[72:75]
    ds_read_b128 a[136:139], v172 offset:10240
    v_cvt_pk_bf16_f32 v148, v136, v137
    v_mfma_f32_16x16x32_bf16 v[76:79], a[172:175], v[144:147], v[76:79]
    v_exp_f32 v138, v138
    v_mfma_f32_16x16x32_bf16 v[80:83], a[176:179], v[144:147], v[80:83]
    v_mfma_f32_16x16x32_bf16 v[84:87], a[180:183], v[144:147], v[84:87]
    v_exp_f32 v139, v139
    v_mfma_f32_16x16x32_bf16 v[88:91], a[184:187], v[144:147], v[88:91]
    ds_read_b128 a[140:143], v172 offset:11264
    v_cvt_pk_bf16_f32 v149, v138, v139
    v_mfma_f32_16x16x32_bf16 v[92:95], a[188:191], v[144:147], v[92:95]
    v_exp_f32 v140, v140
    v_mfma_f32_16x16x32_bf16 v[160:163], v[168:171], v[144:147], v[160:163]
    v_xor_b32 v173, 0x10000, v173
    s_sub_u32 s30, s30, 1
    s_cmp_lg_u32 s30, 0
    s_cbranch_scc1 L_loop
    s_waitcnt lgkmcnt(1)
    v_mfma_f32_16x16x32_bf16 v[128:131], a[64:67], a[0:3], 0
    v_exp_f32 v141, v141
    v_mfma_f32_16x16x32_bf16 v[128:131], a[68:71], a[4:7], v[128:131]
    ds_read_b128 a[144:147], v173 offset:12288
    v_cvt_pk_bf16_f32 v150, v140, v141
    v_mfma_f32_16x16x32_bf16 v[128:131], a[72:75], a[8:11], v[128:131]
    v_exp_f32 v142, v142
    v_mfma_f32_16x16x32_bf16 v[128:131], a[76:79], a[12:15], v[128:131]
    ds_read_b128 a[148:151], v173 offset:13312
    v_mfma_f32_16x16x32_bf16 v[132:135], a[80:83], a[0:3], 0
    v_exp_f32 v143, v143
    v_mfma_f32_16x16x32_bf16 v[132:135], a[84:87], a[4:7], v[132:135]
    ds_read_b128 a[152:155], v173 offset:14336
    v_cvt_pk_bf16_f32 v151, v142, v143
    v_mfma_f32_16x16x32_bf16 v[132:135], a[88:91], a[8:11], v[132:135]
    global_load_lds_dwordx4 v176, s[24:25] sc1
    v_mfma_f32_16x16x32_bf16 v[132:135], a[92:95], a[12:15], v[132:135]
    v_exp_f32 v128, v128
    v_mfma_f32_16x16x32_bf16 v[96:99], a[160:163], v[148:151], v[96:99]
    ds_read_b128 a[156:159], v173 offset:15360
    v_mfma_f32_16x16x32_bf16 v[100:103], a[164:167], v[148:151], v[100:103]
    v_exp_f32 v129, v129
    v_mfma_f32_16x16x32_bf16 v[104:107], a[168:171], v[148:151], v[104:107]
    v_cvt_pk_bf16_f32 v144, v128, v129
    v_mfma_f32_16x16x32_bf16 v[108:111], a[172:175], v[148:151], v[108:111]
    v_exp_f32 v130, v130
    v_mfma_f32_16x16x32_bf16 v[112:115], a[176:179], v[148:151], v[112:115]
    global_load_lds_dwordx4 v176, s[24:25] offset:1024 sc1
    v_mfma_f32_16x16x32_bf16 v[116:119], a[180:183], v[148:151], v[116:119]
    v_exp_f32 v131, v131
    v_mfma_f32_16x16x32_bf16 v[120:123], a[184:187], v[148:151], v[120:123]
    v_cvt_pk_bf16_f32 v145, v130, v131
    v_mfma_f32_16x16x32_bf16 v[124:127], a[188:191], v[148:151], v[124:127]
    v_exp_f32 v132, v132
    v_mfma_f32_16x16x32_bf16 v[164:167], v[168:171], v[148:151], v[164:167]
    global_load_lds_dwordx4 v176, s[24:25] offset:2048 sc1
    v_mfma_f32_16x16x32_bf16 v[136:139], a[64:67], a[16:19], 0
    v_exp_f32 v133, v133
    v_mfma_f32_16x16x32_bf16 v[136:139], a[68:71], a[20:23], v[136:139]
    ds_read_b128 a[96:99], v172 offset:16384
    v_cvt_pk_bf16_f32 v146, v132, v133
    v_mfma_f32_16x16x32_bf16 v[136:139], a[72:75], a[24:27], v[136:139]
    v_exp_f32 v134, v134
    v_mfma_f32_16x16x32_bf16 v[136:139], a[76:79], a[28:31], v[136:139]
    global_load_lds_dwordx4 v176, s[24:25] offset:3072 sc1
    v_mfma_f32_16x16x32_bf16 v[140:143], a[80:83], a[16:19], 0
    v_exp_f32 v135, v135
    v_mfma_f32_16x16x32_bf16 v[140:143], a[84:87], a[20:23], v[140:143]
    ds_read_b128 a[100:103], v172 offset:17408
    v_cvt_pk_bf16_f32 v147, v134, v135
    s_add_u32 m0, m0, 0x1000
    v_mfma_f32_16x16x32_bf16 v[140:143], a[88:91], a[24:27], v[140:143]
    global_load_lds_dwordx4 v177, s[24:25] sc1
    v_mfma_f32_16x16x32_bf16 v[140:143], a[92:95], a[28:31], v[140:143]
    v_exp_f32 v136, v136
    v_mfma_f32_16x16x32_bf16 v[0:3], a[128:131], v[144:147], v[0:3]
    v_mfma_f32_16x16x32_bf16 v[4:7], a[132:135], v[144:147], v[4:7]
    v_exp_f32 v137, v137
    v_mfma_f32_16x16x32_bf16 v[8:11], a[136:139], v[144:147], v[8:11]
    ds_read_b128 a[104:107], v172 offset:18432
    v_cvt_pk_bf16_f32 v148, v136, v137
    s_waitcnt lgkmcnt(2)
    v_mfma_f32_16x16x32_bf16 v[12:15], a[140:143], v[144:147], v[12:15]
    v_exp_f32 v138, v138
    v_mfma_f32_16x16x32_bf16 v[16:19], a[144:147], v[144:147], v[16:19]
    global_load_lds_dwordx4 v177, s[24:25] offset:1024 sc1
    v_mfma_f32_16x16x32_bf16 v[20:23], a[148:151], v[144:147], v[20:23]
    v_exp_f32 v139, v139
    v_mfma_f32_16x16x32_bf16 v[24:27], a[152:155], v[144:147], v[24:27]
    ds_read_b128 a[108:111], v172 offset:19456
    v_cvt_pk_bf16_f32 v149, v138, v139
    v_mfma_f32_16x16x32_bf16 v[28:31], a[156:159], v[144:147], v[28:31]
    v_exp_f32 v140, v140
    v_mfma_f32_16x16x32_bf16 v[152:155], v[168:171], v[144:147], v[152:155]
    global_load_lds_dwordx4 v177, s[24:25] offset:2048 sc1
    v_mfma_f32_16x16x32_bf16 v[128:131], a[64:67], a[32:35], 0
    v_exp_f32 v141, v141
    v_mfma_f32_16x16x32_bf16 v[128:131], a[68:71], a[36:39], v[128:131]
    ds_read_b128 a[112:115], v172 offset:20480
    v_cvt_pk_bf16_f32 v150, v140, v141
    v_mfma_f32_16x16x32_bf16 v[128:131], a[72:75], a[40:43], v[128:131]
    v_exp_f32 v142, v142
    v_mfma_f32_16x16x32_bf16 v[128:131], a[76:79], a[44:47], v[128:131]
    global_load_lds_dwordx4 v177, s[24:25] offset:3072 sc1
    v_mfma_f32_16x16x32_bf16 v[132:135], a[80:83], a[32:35], 0
    v_exp_f32 v143, v143
    v_mfma_f32_16x16x32_bf16 v[132:135], a[84:87], a[36:39], v[132:135]
    ds_read_b128 a[116:119], v172 offset:21504
    v_cvt_pk_bf16_f32 v151, v142, v143
    s_add_u32 m0, m0, 0x1000
    v_mfma_f32_16x16x32_bf16 v[132:135], a[88:91], a[40:43], v[132:135]
    global_load_lds_dwordx4 v178, s[24:25] sc1
    v_mfma_f32_16x16x32_bf16 v[132:135], a[92:95], a[44:47], v[132:135]
    v_exp_f32 v128, v128
    v_mfma_f32_16x16x32_bf16 v[32:35], a[128:131], v[148:151], v[32:35]
    v_mfma_f32_16x16x32_bf16 v[36:39], a[132:135], v[148:151], v[36:39]
    v_exp_f32 v129, v129
    v_mfma_f32_16x16x32_bf16 v[40:43], a[136:139], v[148:151], v[40:43]
    ds_read_b128 a[120:123], v172 offset:22528
    v_cvt_pk_bf16_f32 v144, v128, v129
    v_mfma_f32_16x16x32_bf16 v[44:47], a[140:143], v[148:151], v[44:47]
    v_exp_f32 v130, v130
    v_mfma_f32_16x16x32_bf16 v[48:51], a[144:147], v[148:151], v[48:51]
    global_load_lds_dwordx4 v178, s[24:25] offset:1024 sc1
    v_mfma_f32_16x16x32_bf16 v[52:55], a[148:151], v[148:151], v[52:55]
    v_exp_f32 v131, v131
    v_mfma_f32_16x16x32_bf16 v[56:59], a[152:155], v[148:151], v[56:59]
    ds_read_b128 a[124:127], v172 offset:23552
    v_cvt_pk_bf16_f32 v145, v130, v131
    v_mfma_f32_16x16x32_bf16 v[60:63], a[156:159], v[148:151], v[60:63]
    v_exp_f32 v132, v132
    v_mfma_f32_16x16x32_bf16 v[156:159], v[168:171], v[148:151], v[156:159]
    global_load_lds_dwordx4 v178, s[24:25] offset:2048 sc1
    v_mfma_f32_16x16x32_bf16 v[136:139], a[64:67], a[48:51], 0
    v_exp_f32 v133, v133
    v_mfma_f32_16x16x32_bf16 v[136:139], a[68:71], a[52:55], v[136:139]
    ds_read_b128 a[160:163], v172 offset:24576
    v_cvt_pk_bf16_f32 v146, v132, v133
    v_mfma_f32_16x16x32_bf16 v[136:139], a[72:75], a[56:59], v[136:139]
    v_exp_f32 v134, v134
    v_mfma_f32_16x16x32_bf16 v[136:139], a[76:79], a[60:63], v[136:139]
    global_load_lds_dwordx4 v178, s[24:25] offset:3072 sc1
    v_mfma_f32_16x16x32_bf16 v[140:143], a[80:83], a[48:51], 0
    v_exp_f32 v135, v135
    v_mfma_f32_16x16x32_bf16 v[140:143], a[84:87], a[52:55], v[140:143]
    ds_read_b128 a[164:167], v172 offset:25600
    v_cvt_pk_bf16_f32 v147, v134, v135
    s_add_u32 m0, m0, 0x1000
    v_mfma_f32_16x16x32_bf16 v[140:143], a[88:91], a[56:59], v[140:143]
    global_load_lds_dwordx4 v179, s[24:25] sc1
    v_mfma_f32_16x16x32_bf16 v[140:143], a[92:95], a[60:63], v[140:143]
    v_exp_f32 v136, v136
    v_mfma_f32_16x16x32_bf16 v[64:67], a[128:131], v[144:147], v[64:67]
    v_mfma_f32_16x16x32_bf16 v[68:71], a[132:135], v[144:147], v[68:71]
    v_exp_f32 v137, v137
    v_mfma_f32_16x16x32_bf16 v[72:75], a[136:139], v[144:147], v[72:75]
    ds_read_b128 a[168:171], v172 offset:26624
    v_cvt_pk_bf16_f32 v148, v136, v137
    v_mfma_f32_16x16x32_bf16 v[76:79], a[140:143], v[144:147], v[76:79]
    v_exp_f32 v138, v138
    v_mfma_f32_16x16x32_bf16 v[80:83], a[144:147], v[144:147], v[80:83]
    global_load_lds_dwordx4 v179, s[24:25] offset:1024 sc1
    v_mfma_f32_16x16x32_bf16 v[84:87], a[148:151], v[144:147], v[84:87]
    v_exp_f32 v139, v139
    v_mfma_f32_16x16x32_bf16 v[88:91], a[152:155], v[144:147], v[88:91]
    ds_read_b128 a[172:175], v172 offset:27648
    v_cvt_pk_bf16_f32 v149, v138, v139
    v_mfma_f32_16x16x32_bf16 v[92:95], a[156:159], v[144:147], v[92:95]
    v_exp_f32 v140, v140
    v_mfma_f32_16x16x32_bf16 v[160:163], v[168:171], v[144:147], v[160:163]
    global_load_lds_dwordx4 v179, s[24:25] offset:2048 sc1
    v_mfma_f32_16x16x32_bf16 v[128:131], a[96:99], a[0:3], 0
    v_exp_f32 v141, v141
    s_waitcnt lgkmcnt(1)
    v_mfma_f32_16x16x32_bf16 v[128:131], a[100:103], a[4:7], v[128:131]
    ds_read_b128 a[176:179], v173 offset:28672
    v_cvt_pk_bf16_f32 v150, v140, v141
    v_mfma_f32_16x16x32_bf16 v[128:131], a[104:107], a[8:11], v[128:131]
    v_exp_f32 v142, v142
    v_mfma_f32_16x16x32_bf16 v[128:131], a[108:111], a[12:15], v[128:131]
    ds_read_b128 a[180:183], v173 offset:29696
    v_mfma_f32_16x16x32_bf16 v[132:135], a[112:115], a[0:3], 0
    v_exp_f32 v143, v143
    v_mfma_f32_16x16x32_bf16 v[132:135], a[116:119], a[4:7], v[132:135]
    ds_read_b128 a[184:187], v173 offset:30720
    v_cvt_pk_bf16_f32 v151, v142, v143
    v_mfma_f32_16x16x32_bf16 v[132:135], a[120:123], a[8:11], v[132:135]
    global_load_lds_dwordx4 v179, s[24:25] offset:3072 sc1
    v_mfma_f32_16x16x32_bf16 v[132:135], a[124:127], a[12:15], v[132:135]
    v_exp_f32 v128, v128
    s_add_u32 s24, s24, 0x10000
    s_addc_u32 s25, s25, 0
    v_mfma_f32_16x16x32_bf16 v[96:99], a[128:131], v[148:151], v[96:99]
    ds_read_b128 a[188:191], v173 offset:31744
    v_mfma_f32_16x16x32_bf16 v[100:103], a[132:135], v[148:151], v[100:103]
    v_exp_f32 v129, v129
    v_mfma_f32_16x16x32_bf16 v[104:107], a[136:139], v[148:151], v[104:107]
    v_cvt_pk_bf16_f32 v144, v128, v129
    v_mfma_f32_16x16x32_bf16 v[108:111], a[140:143], v[148:151], v[108:111]
    v_exp_f32 v130, v130
    v_mfma_f32_16x16x32_bf16 v[112:115], a[144:147], v[148:151], v[112:115]
    v_mfma_f32_16x16x32_bf16 v[116:119], a[148:151], v[148:151], v[116:119]
    v_exp_f32 v131, v131
    v_mfma_f32_16x16x32_bf16 v[120:123], a[152:155], v[148:151], v[120:123]
    v_cvt_pk_bf16_f32 v145, v130, v131
    v_mfma_f32_16x16x32_bf16 v[124:127], a[156:159], v[148:151], v[124:127]
    v_exp_f32 v132, v132
    v_mfma_f32_16x16x32_bf16 v[164:167], v[168:171], v[148:151], v[164:167]
    v_mfma_f32_16x16x32_bf16 v[136:139], a[96:99], a[16:19], 0
    v_exp_f32 v133, v133
    v_mfma_f32_16x16x32_bf16 v[136:139], a[100:103], a[20:23], v[136:139]
    ds_read_b128 a[64:67], v172 offset:32768
    v_cvt_pk_bf16_f32 v146, v132, v133
    v_mfma_f32_16x16x32_bf16 v[136:139], a[104:107], a[24:27], v[136:139]
    v_exp_f32 v134, v134
    v_mfma_f32_16x16x32_bf16 v[136:139], a[108:111], a[28:31], v[136:139]
    v_mfma_f32_16x16x32_bf16 v[140:143], a[112:115], a[16:19], 0
    v_exp_f32 v135, v135
    v_mfma_f32_16x16x32_bf16 v[140:143], a[116:119], a[20:23], v[140:143]
    ds_read_b128 a[68:71], v172 offset:33792
    v_cvt_pk_bf16_f32 v147, v134, v135
    v_mfma_f32_16x16x32_bf16 v[140:143], a[120:123], a[24:27], v[140:143]
    v_mfma_f32_16x16x32_bf16 v[140:143], a[124:127], a[28:31], v[140:143]
    v_exp_f32 v136, v136
    v_mfma_f32_16x16x32_bf16 v[0:3], a[160:163], v[144:147], v[0:3]
    v_mfma_f32_16x16x32_bf16 v[4:7], a[164:167], v[144:147], v[4:7]
    v_exp_f32 v137, v137
    v_mfma_f32_16x16x32_bf16 v[8:11], a[168:171], v[144:147], v[8:11]
    ds_read_b128 a[72:75], v172 offset:34816
    v_cvt_pk_bf16_f32 v148, v136, v137
    s_waitcnt lgkmcnt(2)
    v_mfma_f32_16x16x32_bf16 v[12:15], a[172:175], v[144:147], v[12:15]
    v_exp_f32 v138, v138
    v_mfma_f32_16x16x32_bf16 v[16:19], a[176:179], v[144:147], v[16:19]
    v_mfma_f32_16x16x32_bf16 v[20:23], a[180:183], v[144:147], v[20:23]
    v_exp_f32 v139, v139
    v_mfma_f32_16x16x32_bf16 v[24:27], a[184:187], v[144:147], v[24:27]
    ds_read_b128 a[76:79], v172 offset:35840
    v_cvt_pk_bf16_f32 v149, v138, v139
    v_mfma_f32_16x16x32_bf16 v[28:31], a[188:191], v[144:147], v[28:31]
    v_exp_f32 v140, v140
    v_mfma_f32_16x16x32_bf16 v[152:155], v[168:171], v[144:147], v[152:155]
    v_mfma_f32_16x16x32_bf16 v[128:131], a[96:99], a[32:35], 0
    v_exp_f32 v141, v141
    v_mfma_f32_16x16x32_bf16 v[128:131], a[100:103], a[36:39], v[128:131]
    ds_read_b128 a[80:83], v172 offset:36864
    v_cvt_pk_bf16_f32 v150, v140, v141
    v_mfma_f32_16x16x32_bf16 v[128:131], a[104:107], a[40:43], v[128:131]
    v_exp_f32 v142, v142
    v_mfma_f32_16x16x32_bf16 v[128:131], a[108:111], a[44:47], v[128:131]
    v_mfma_f32_16x16x32_bf16 v[132:135], a[112:115], a[32:35], 0
    v_exp_f32 v143, v143
    v_mfma_f32_16x16x32_bf16 v[132:135], a[116:119], a[36:39], v[132:135]
    ds_read_b128 a[84:87], v172 offset:37888
    v_cvt_pk_bf16_f32 v151, v142, v143
    v_mfma_f32_16x16x32_bf16 v[132:135], a[120:123], a[40:43], v[132:135]
    v_mfma_f32_16x16x32_bf16 v[132:135], a[124:127], a[44:47], v[132:135]
    v_exp_f32 v128, v128
    v_mfma_f32_16x16x32_bf16 v[32:35], a[160:163], v[148:151], v[32:35]
    v_mfma_f32_16x16x32_bf16 v[36:39], a[164:167], v[148:151], v[36:39]
    v_exp_f32 v129, v129
    v_mfma_f32_16x16x32_bf16 v[40:43], a[168:171], v[148:151], v[40:43]
    ds_read_b128 a[88:91], v172 offset:38912
    v_cvt_pk_bf16_f32 v144, v128, v129
    v_mfma_f32_16x16x32_bf16 v[44:47], a[172:175], v[148:151], v[44:47]
    v_exp_f32 v130, v130
    v_mfma_f32_16x16x32_bf16 v[48:51], a[176:179], v[148:151], v[48:51]
    v_mfma_f32_16x16x32_bf16 v[52:55], a[180:183], v[148:151], v[52:55]
    v_exp_f32 v131, v131
    v_mfma_f32_16x16x32_bf16 v[56:59], a[184:187], v[148:151], v[56:59]
    ds_read_b128 a[92:95], v172 offset:39936
    v_cvt_pk_bf16_f32 v145, v130, v131
    v_mfma_f32_16x16x32_bf16 v[60:63], a[188:191], v[148:151], v[60:63]
    v_exp_f32 v132, v132
    v_mfma_f32_16x16x32_bf16 v[156:159], v[168:171], v[148:151], v[156:159]
    v_mfma_f32_16x16x32_bf16 v[136:139], a[96:99], a[48:51], 0
    v_exp_f32 v133, v133
    v_mfma_f32_16x16x32_bf16 v[136:139], a[100:103], a[52:55], v[136:139]
    ds_read_b128 a[128:131], v172 offset:40960
    v_cvt_pk_bf16_f32 v146, v132, v133
    v_mfma_f32_16x16x32_bf16 v[136:139], a[104:107], a[56:59], v[136:139]
    v_exp_f32 v134, v134
    v_mfma_f32_16x16x32_bf16 v[136:139], a[108:111], a[60:63], v[136:139]
    v_mfma_f32_16x16x32_bf16 v[140:143], a[112:115], a[48:51], 0
    v_exp_f32 v135, v135
    v_mfma_f32_16x16x32_bf16 v[140:143], a[116:119], a[52:55], v[140:143]
    ds_read_b128 a[132:135], v172 offset:41984
    v_cvt_pk_bf16_f32 v147, v134, v135
    v_mfma_f32_16x16x32_bf16 v[140:143], a[120:123], a[56:59], v[140:143]
    v_mfma_f32_16x16x32_bf16 v[140:143], a[124:127], a[60:63], v[140:143]
    v_exp_f32 v136, v136
    v_mfma_f32_16x16x32_bf16 v[64:67], a[160:163], v[144:147], v[64:67]
    v_mfma_f32_16x16x32_bf16 v[68:71], a[164:167], v[144:147], v[68:71]
    v_exp_f32 v137, v137
    v_mfma_f32_16x16x32_bf16 v[72:75], a[168:171], v[144:147], v[72:75]
    ds_read_b128 a[136:139], v172 offset:43008
    v_cvt_pk_bf16_f32 v148, v136, v137
    v_mfma_f32_16x16x32_bf16 v[76:79], a[172:175], v[144:147], v[76:79]
    v_exp_f32 v138, v138
    v_mfma_f32_16x16x32_bf16 v[80:83], a[176:179], v[144:147], v[80:83]
    v_mfma_f32_16x16x32_bf16 v[84:87], a[180:183], v[144:147], v[84:87]
    v_exp_f32 v139, v139
    v_mfma_f32_16x16x32_bf16 v[88:91], a[184:187], v[144:147], v[88:91]
    ds_read_b128 a[140:143], v172 offset:44032
    v_cvt_pk_bf16_f32 v149, v138, v139
    v_mfma_f32_16x16x32_bf16 v[92:95], a[188:191], v[144:147], v[92:95]
    v_exp_f32 v140, v140
    v_mfma_f32_16x16x32_bf16 v[160:163], v[168:171], v[144:147], v[160:163]
    v_mfma_f32_16x16x32_bf16 v[128:131], a[64:67], a[0:3], 0
    v_exp_f32 v141, v141
    s_waitcnt lgkmcnt(1)
    v_mfma_f32_16x16x32_bf16 v[128:131], a[68:71], a[4:7], v[128:131]
    ds_read_b128 a[144:147], v173 offset:45056
    v_cvt_pk_bf16_f32 v150, v140, v141
    v_mfma_f32_16x16x32_bf16 v[128:131], a[72:75], a[8:11], v[128:131]
    v_exp_f32 v142, v142
    v_mfma_f32_16x16x32_bf16 v[128:131], a[76:79], a[12:15], v[128:131]
    ds_read_b128 a[148:151], v173 offset:46080
    v_mfma_f32_16x16x32_bf16 v[132:135], a[80:83], a[0:3], 0
    v_exp_f32 v143, v143
    v_mfma_f32_16x16x32_bf16 v[132:135], a[84:87], a[4:7], v[132:135]
    ds_read_b128 a[152:155], v173 offset:47104
    v_cvt_pk_bf16_f32 v151, v142, v143
    v_mfma_f32_16x16x32_bf16 v[132:135], a[88:91], a[8:11], v[132:135]
    v_mfma_f32_16x16x32_bf16 v[132:135], a[92:95], a[12:15], v[132:135]
    v_exp_f32 v128, v128
    v_mfma_f32_16x16x32_bf16 v[96:99], a[160:163], v[148:151], v[96:99]
    ds_read_b128 a[156:159], v173 offset:48128
    v_mfma_f32_16x16x32_bf16 v[100:103], a[164:167], v[148:151], v[100:103]
    v_exp_f32 v129, v129
    v_mfma_f32_16x16x32_bf16 v[104:107], a[168:171], v[148:151], v[104:107]
    v_cvt_pk_bf16_f32 v144, v128, v129
    v_mfma_f32_16x16x32_bf16 v[108:111], a[172:175], v[148:151], v[108:111]
    v_exp_f32 v130, v130
    v_mfma_f32_16x16x32_bf16 v[112:115], a[176:179], v[148:151], v[112:115]
    v_mfma_f32_16x16x32_bf16 v[116:119], a[180:183], v[148:151], v[116:119]
    v_exp_f32 v131, v131
    v_mfma_f32_16x16x32_bf16 v[120:123], a[184:187], v[148:151], v[120:123]
    v_cvt_pk_bf16_f32 v145, v130, v131
    v_mfma_f32_16x16x32_bf16 v[124:127], a[188:191], v[148:151], v[124:127]
    v_exp_f32 v132, v132
    v_mfma_f32_16x16x32_bf16 v[164:167], v[168:171], v[148:151], v[164:167]
    v_mfma_f32_16x16x32_bf16 v[136:139], a[64:67], a[16:19], 0
    v_exp_f32 v133, v133
    v_mfma_f32_16x16x32_bf16 v[136:139], a[68:71], a[20:23], v[136:139]
    ds_read_b128 a[96:99], v172 offset:49152
    v_cvt_pk_bf16_f32 v146, v132, v133
    v_mfma_f32_16x16x32_bf16 v[136:139], a[72:75], a[24:27], v[136:139]
    v_exp_f32 v134, v134
    v_mfma_f32_16x16x32_bf16 v[136:139], a[76:79], a[28:31], v[136:139]
    v_mfma_f32_16x16x32_bf16 v[140:143], a[80:83], a[16:19], 0
    v_exp_f32 v135, v135
    v_mfma_f32_16x16x32_bf16 v[140:143], a[84:87], a[20:23], v[140:143]
    ds_read_b128 a[100:103], v172 offset:50176
    v_cvt_pk_bf16_f32 v147, v134, v135
    v_mfma_f32_16x16x32_bf16 v[140:143], a[88:91], a[24:27], v[140:143]
    v_mfma_f32_16x16x32_bf16 v[140:143], a[92:95], a[28:31], v[140:143]
    v_exp_f32 v136, v136
    v_mfma_f32_16x16x32_bf16 v[0:3], a[128:131], v[144:147], v[0:3]
    v_mfma_f32_16x16x32_bf16 v[4:7], a[132:135], v[144:147], v[4:7]
    v_exp_f32 v137, v137
    v_mfma_f32_16x16x32_bf16 v[8:11], a[136:139], v[144:147], v[8:11]
    ds_read_b128 a[104:107], v172 offset:51200
    v_cvt_pk_bf16_f32 v148, v136, v137
    s_waitcnt lgkmcnt(2)
    v_mfma_f32_16x16x32_bf16 v[12:15], a[140:143], v[144:147], v[12:15]
    v_exp_f32 v138, v138
    v_mfma_f32_16x16x32_bf16 v[16:19], a[144:147], v[144:147], v[16:19]
    v_mfma_f32_16x16x32_bf16 v[20:23], a[148:151], v[144:147], v[20:23]
    v_exp_f32 v139, v139
    v_mfma_f32_16x16x32_bf16 v[24:27], a[152:155], v[144:147], v[24:27]
    ds_read_b128 a[108:111], v172 offset:52224
    v_cvt_pk_bf16_f32 v149, v138, v139
    v_mfma_f32_16x16x32_bf16 v[28:31], a[156:159], v[144:147], v[28:31]
    v_exp_f32 v140, v140
    v_mfma_f32_16x16x32_bf16 v[152:155], v[168:171], v[144:147], v[152:155]
    v_mfma_f32_16x16x32_bf16 v[128:131], a[64:67], a[32:35], 0
    v_exp_f32 v141, v141
    v_mfma_f32_16x16x32_bf16 v[128:131], a[68:71], a[36:39], v[128:131]
    ds_read_b128 a[112:115], v172 offset:53248
    v_cvt_pk_bf16_f32 v150, v140, v141
    v_mfma_f32_16x16x32_bf16 v[128:131], a[72:75], a[40:43], v[128:131]
    v_exp_f32 v142, v142
    v_mfma_f32_16x16x32_bf16 v[128:131], a[76:79], a[44:47], v[128:131]
    v_mfma_f32_16x16x32_bf16 v[132:135], a[80:83], a[32:35], 0
    v_exp_f32 v143, v143
    v_mfma_f32_16x16x32_bf16 v[132:135], a[84:87], a[36:39], v[132:135]
    ds_read_b128 a[116:119], v172 offset:54272
    v_cvt_pk_bf16_f32 v151, v142, v143
    v_mfma_f32_16x16x32_bf16 v[132:135], a[88:91], a[40:43], v[132:135]
    v_mfma_f32_16x16x32_bf16 v[132:135], a[92:95], a[44:47], v[132:135]
    v_exp_f32 v128, v128
    v_mfma_f32_16x16x32_bf16 v[32:35], a[128:131], v[148:151], v[32:35]
    v_mfma_f32_16x16x32_bf16 v[36:39], a[132:135], v[148:151], v[36:39]
    v_exp_f32 v129, v129
    v_mfma_f32_16x16x32_bf16 v[40:43], a[136:139], v[148:151], v[40:43]
    ds_read_b128 a[120:123], v172 offset:55296
    v_cvt_pk_bf16_f32 v144, v128, v129
    v_mfma_f32_16x16x32_bf16 v[44:47], a[140:143], v[148:151], v[44:47]
    v_exp_f32 v130, v130
    v_mfma_f32_16x16x32_bf16 v[48:51], a[144:147], v[148:151], v[48:51]
    v_mfma_f32_16x16x32_bf16 v[52:55], a[148:151], v[148:151], v[52:55]
    v_exp_f32 v131, v131
    v_mfma_f32_16x16x32_bf16 v[56:59], a[152:155], v[148:151], v[56:59]
    ds_read_b128 a[124:127], v172 offset:56320
    v_cvt_pk_bf16_f32 v145, v130, v131
    v_mfma_f32_16x16x32_bf16 v[60:63], a[156:159], v[148:151], v[60:63]
    v_exp_f32 v132, v132
    v_mfma_f32_16x16x32_bf16 v[156:159], v[168:171], v[148:151], v[156:159]
    v_mfma_f32_16x16x32_bf16 v[136:139], a[64:67], a[48:51], 0
    v_exp_f32 v133, v133
    v_mfma_f32_16x16x32_bf16 v[136:139], a[68:71], a[52:55], v[136:139]
    ds_read_b128 a[160:163], v172 offset:57344
    v_cvt_pk_bf16_f32 v146, v132, v133
    v_mfma_f32_16x16x32_bf16 v[136:139], a[72:75], a[56:59], v[136:139]
    v_exp_f32 v134, v134
    v_mfma_f32_16x16x32_bf16 v[136:139], a[76:79], a[60:63], v[136:139]
    v_mfma_f32_16x16x32_bf16 v[140:143], a[80:83], a[48:51], 0
    v_exp_f32 v135, v135
    v_mfma_f32_16x16x32_bf16 v[140:143], a[84:87], a[52:55], v[140:143]
    ds_read_b128 a[164:167], v172 offset:58368
    v_cvt_pk_bf16_f32 v147, v134, v135
    v_mfma_f32_16x16x32_bf16 v[140:143], a[88:91], a[56:59], v[140:143]
    v_mfma_f32_16x16x32_bf16 v[140:143], a[92:95], a[60:63], v[140:143]
    v_exp_f32 v136, v136
    v_mfma_f32_16x16x32_bf16 v[64:67], a[128:131], v[144:147], v[64:67]
    v_mfma_f32_16x16x32_bf16 v[68:71], a[132:135], v[144:147], v[68:71]
    v_exp_f32 v137, v137
    v_mfma_f32_16x16x32_bf16 v[72:75], a[136:139], v[144:147], v[72:75]
    ds_read_b128 a[168:171], v172 offset:59392
    v_cvt_pk_bf16_f32 v148, v136, v137
    v_mfma_f32_16x16x32_bf16 v[76:79], a[140:143], v[144:147], v[76:79]
    v_exp_f32 v138, v138
    v_mfma_f32_16x16x32_bf16 v[80:83], a[144:147], v[144:147], v[80:83]
    v_mfma_f32_16x16x32_bf16 v[84:87], a[148:151], v[144:147], v[84:87]
    v_exp_f32 v139, v139
    v_mfma_f32_16x16x32_bf16 v[88:91], a[152:155], v[144:147], v[88:91]
    ds_read_b128 a[172:175], v172 offset:60416
    v_cvt_pk_bf16_f32 v149, v138, v139
    v_mfma_f32_16x16x32_bf16 v[92:95], a[156:159], v[144:147], v[92:95]
    v_exp_f32 v140, v140
    v_mfma_f32_16x16x32_bf16 v[160:163], v[168:171], v[144:147], v[160:163]
    v_mfma_f32_16x16x32_bf16 v[128:131], a[96:99], a[0:3], 0
    v_exp_f32 v141, v141
    s_waitcnt lgkmcnt(1)
    v_mfma_f32_16x16x32_bf16 v[128:131], a[100:103], a[4:7], v[128:131]
    ds_read_b128 a[176:179], v173 offset:61440
    v_cvt_pk_bf16_f32 v150, v140, v141
    v_mfma_f32_16x16x32_bf16 v[128:131], a[104:107], a[8:11], v[128:131]
    v_exp_f32 v142, v142
    v_mfma_f32_16x16x32_bf16 v[128:131], a[108:111], a[12:15], v[128:131]
    ds_read_b128 a[180:183], v173 offset:62464
    v_mfma_f32_16x16x32_bf16 v[132:135], a[112:115], a[0:3], 0
    v_exp_f32 v143, v143
    v_mfma_f32_16x16x32_bf16 v[132:135], a[116:119], a[4:7], v[132:135]
    ds_read_b128 a[184:187], v173 offset:63488
    v_cvt_pk_bf16_f32 v151, v142, v143
    v_mfma_f32_16x16x32_bf16 v[132:135], a[120:123], a[8:11], v[132:135]
    v_mfma_f32_16x16x32_bf16 v[132:135], a[124:127], a[12:15], v[132:135]
    v_exp_f32 v128, v128
    v_mfma_f32_16x16x32_bf16 v[96:99], a[128:131], v[148:151], v[96:99]
    ds_read_b128 a[188:191], v173 offset:64512
    v_mfma_f32_16x16x32_bf16 v[100:103], a[132:135], v[148:151], v[100:103]
    v_exp_f32 v129, v129
    v_mfma_f32_16x16x32_bf16 v[104:107], a[136:139], v[148:151], v[104:107]
    v_cvt_pk_bf16_f32 v144, v128, v129
    v_mfma_f32_16x16x32_bf16 v[108:111], a[140:143], v[148:151], v[108:111]
    v_exp_f32 v130, v130
    v_mfma_f32_16x16x32_bf16 v[112:115], a[144:147], v[148:151], v[112:115]
    v_mfma_f32_16x16x32_bf16 v[116:119], a[148:151], v[148:151], v[116:119]
    v_exp_f32 v131, v131
    v_mfma_f32_16x16x32_bf16 v[120:123], a[152:155], v[148:151], v[120:123]
    v_cvt_pk_bf16_f32 v145, v130, v131
    v_mfma_f32_16x16x32_bf16 v[124:127], a[156:159], v[148:151], v[124:127]
    v_exp_f32 v132, v132
    v_mfma_f32_16x16x32_bf16 v[164:167], v[168:171], v[148:151], v[164:167]
    s_waitcnt vmcnt(0) lgkmcnt(0)
    s_barrier
    v_xor_b32 v172, 0x10000, v172
    v_mfma_f32_16x16x32_bf16 v[136:139], a[96:99], a[16:19], 0
    v_exp_f32 v133, v133
    v_mfma_f32_16x16x32_bf16 v[136:139], a[100:103], a[20:23], v[136:139]
    ds_read_b128 a[64:67], v172
    v_cvt_pk_bf16_f32 v146, v132, v133
    v_mfma_f32_16x16x32_bf16 v[136:139], a[104:107], a[24:27], v[136:139]
    v_exp_f32 v134, v134
    v_mfma_f32_16x16x32_bf16 v[136:139], a[108:111], a[28:31], v[136:139]
    v_mfma_f32_16x16x32_bf16 v[140:143], a[112:115], a[16:19], 0
    v_exp_f32 v135, v135
    v_mfma_f32_16x16x32_bf16 v[140:143], a[116:119], a[20:23], v[140:143]
    ds_read_b128 a[68:71], v172 offset:1024
    v_cvt_pk_bf16_f32 v147, v134, v135
    v_mfma_f32_16x16x32_bf16 v[140:143], a[120:123], a[24:27], v[140:143]
    v_mfma_f32_16x16x32_bf16 v[140:143], a[124:127], a[28:31], v[140:143]
    v_exp_f32 v136, v136
    v_mfma_f32_16x16x32_bf16 v[0:3], a[160:163], v[144:147], v[0:3]
    v_mfma_f32_16x16x32_bf16 v[4:7], a[164:167], v[144:147], v[4:7]
    v_exp_f32 v137, v137
    v_mfma_f32_16x16x32_bf16 v[8:11], a[168:171], v[144:147], v[8:11]
    ds_read_b128 a[72:75], v172 offset:2048
    v_cvt_pk_bf16_f32 v148, v136, v137
    v_mfma_f32_16x16x32_bf16 v[12:15], a[172:175], v[144:147], v[12:15]
    v_exp_f32 v138, v138
    v_mfma_f32_16x16x32_bf16 v[16:19], a[176:179], v[144:147], v[16:19]
    v_mfma_f32_16x16x32_bf16 v[20:23], a[180:183], v[144:147], v[20:23]
    v_exp_f32 v139, v139
    v_mfma_f32_16x16x32_bf16 v[24:27], a[184:187], v[144:147], v[24:27]
    ds_read_b128 a[76:79], v172 offset:3072
    v_cvt_pk_bf16_f32 v149, v138, v139
    v_mfma_f32_16x16x32_bf16 v[28:31], a[188:191], v[144:147], v[28:31]
    v_exp_f32 v140, v140
    v_mfma_f32_16x16x32_bf16 v[152:155], v[168:171], v[144:147], v[152:155]
    v_mfma_f32_16x16x32_bf16 v[128:131], a[96:99], a[32:35], 0
    v_exp_f32 v141, v141
    v_mfma_f32_16x16x32_bf16 v[128:131], a[100:103], a[36:39], v[128:131]
    ds_read_b128 a[80:83], v172 offset:4096
    v_cvt_pk_bf16_f32 v150, v140, v141
    v_mfma_f32_16x16x32_bf16 v[128:131], a[104:107], a[40:43], v[128:131]
    v_exp_f32 v142, v142
    v_mfma_f32_16x16x32_bf16 v[128:131], a[108:111], a[44:47], v[128:131]
    v_mfma_f32_16x16x32_bf16 v[132:135], a[112:115], a[32:35], 0
    v_exp_f32 v143, v143
    v_mfma_f32_16x16x32_bf16 v[132:135], a[116:119], a[36:39], v[132:135]
    ds_read_b128 a[84:87], v172 offset:5120
    v_cvt_pk_bf16_f32 v151, v142, v143
    v_mfma_f32_16x16x32_bf16 v[132:135], a[120:123], a[40:43], v[132:135]
    v_mfma_f32_16x16x32_bf16 v[132:135], a[124:127], a[44:47], v[132:135]
    v_exp_f32 v128, v128
    v_mfma_f32_16x16x32_bf16 v[32:35], a[160:163], v[148:151], v[32:35]
    v_mfma_f32_16x16x32_bf16 v[36:39], a[164:167], v[148:151], v[36:39]
    v_exp_f32 v129, v129
    v_mfma_f32_16x16x32_bf16 v[40:43], a[168:171], v[148:151], v[40:43]
    ds_read_b128 a[88:91], v172 offset:6144
    v_cvt_pk_bf16_f32 v144, v128, v129
    v_mfma_f32_16x16x32_bf16 v[44:47], a[172:175], v[148:151], v[44:47]
    v_exp_f32 v130, v130
    v_mfma_f32_16x16x32_bf16 v[48:51], a[176:179], v[148:151], v[48:51]
    v_mfma_f32_16x16x32_bf16 v[52:55], a[180:183], v[148:151], v[52:55]
    v_exp_f32 v131, v131
    v_mfma_f32_16x16x32_bf16 v[56:59], a[184:187], v[148:151], v[56:59]
    ds_read_b128 a[92:95], v172 offset:7168
    v_cvt_pk_bf16_f32 v145, v130, v131
    v_mfma_f32_16x16x32_bf16 v[60:63], a[188:191], v[148:151], v[60:63]
    v_exp_f32 v132, v132
    v_mfma_f32_16x16x32_bf16 v[156:159], v[168:171], v[148:151], v[156:159]
    v_mfma_f32_16x16x32_bf16 v[136:139], a[96:99], a[48:51], 0
    v_exp_f32 v133, v133
    v_mfma_f32_16x16x32_bf16 v[136:139], a[100:103], a[52:55], v[136:139]
    ds_read_b128 a[128:131], v172 offset:8192
    v_cvt_pk_bf16_f32 v146, v132, v133
    v_mfma_f32_16x16x32_bf16 v[136:139], a[104:107], a[56:59], v[136:139]
    v_exp_f32 v134, v134
    v_mfma_f32_16x16x32_bf16 v[136:139], a[108:111], a[60:63], v[136:139]
    v_mfma_f32_16x16x32_bf16 v[140:143], a[112:115], a[48:51], 0
    v_exp_f32 v135, v135
    v_mfma_f32_16x16x32_bf16 v[140:143], a[116:119], a[52:55], v[140:143]
    ds_read_b128 a[132:135], v172 offset:9216
    v_cvt_pk_bf16_f32 v147, v134, v135
    v_mfma_f32_16x16x32_bf16 v[140:143], a[120:123], a[56:59], v[140:143]
    v_mfma_f32_16x16x32_bf16 v[140:143], a[124:127], a[60:63], v[140:143]
    v_exp_f32 v136, v136
    v_mfma_f32_16x16x32_bf16 v[64:67], a[160:163], v[144:147], v[64:67]
    v_mfma_f32_16x16x32_bf16 v[68:71], a[164:167], v[144:147], v[68:71]
    v_exp_f32 v137, v137
    v_mfma_f32_16x16x32_bf16 v[72:75], a[168:171], v[144:147], v[72:75]
    ds_read_b128 a[136:139], v172 offset:10240
    v_cvt_pk_bf16_f32 v148, v136, v137
    v_mfma_f32_16x16x32_bf16 v[76:79], a[172:175], v[144:147], v[76:79]
    v_exp_f32 v138, v138
    v_mfma_f32_16x16x32_bf16 v[80:83], a[176:179], v[144:147], v[80:83]
    v_mfma_f32_16x16x32_bf16 v[84:87], a[180:183], v[144:147], v[84:87]
    v_exp_f32 v139, v139
    v_mfma_f32_16x16x32_bf16 v[88:91], a[184:187], v[144:147], v[88:91]
    ds_read_b128 a[140:143], v172 offset:11264
    v_cvt_pk_bf16_f32 v149, v138, v139
    v_mfma_f32_16x16x32_bf16 v[92:95], a[188:191], v[144:147], v[92:95]
    v_exp_f32 v140, v140
    v_mfma_f32_16x16x32_bf16 v[160:163], v[168:171], v[144:147], v[160:163]
    v_xor_b32 v173, 0x10000, v173
    s_waitcnt lgkmcnt(1)
    v_mfma_f32_16x16x32_bf16 v[128:131], a[64:67], a[0:3], 0
    v_exp_f32 v141, v141
    v_mfma_f32_16x16x32_bf16 v[128:131], a[68:71], a[4:7], v[128:131]
    ds_read_b128 a[144:147], v173 offset:12288
    v_cvt_pk_bf16_f32 v150, v140, v141
    v_mfma_f32_16x16x32_bf16 v[128:131], a[72:75], a[8:11], v[128:131]
    v_exp_f32 v142, v142
    v_and_b32 v216, 15, v175
    s_mov_b32 s8, s56
    s_and_b32 s9, s57, 0xffff
    s_mov_b32 s10, 0x10000
    s_mov_b32 s11, 0x20000
    v_mfma_f32_16x16x32_bf16 v[128:131], a[76:79], a[12:15], v[128:131]
    ds_read_b128 a[148:151], v173 offset:13312
    v_lshlrev_b32 v216, 8, v216
    v_bfe_u32 v219, v175, 4, 1
    v_mfma_f32_16x16x32_bf16 v[132:135], a[80:83], a[0:3], 0
    v_exp_f32 v143, v143
    v_lshlrev_b32 v219, 5, v219
    v_mfma_f32_16x16x32_bf16 v[132:135], a[84:87], a[4:7], v[132:135]
    ds_read_b128 a[152:155], v173 offset:14336
    v_cvt_pk_bf16_f32 v151, v142, v143
    v_add_u32 v216, v216, v219
    v_mfma_f32_16x16x32_bf16 v[132:135], a[88:91], a[8:11], v[132:135]
    v_lshrrev_b32 v219, 5, v175
    v_lshlrev_b32 v219, 4, v219
    v_add_u32 v216, v216, v219
    s_lshl_b32 s90, s28, 14
    v_mfma_f32_16x16x32_bf16 v[132:135], a[92:95], a[12:15], v[132:135]
    v_exp_f32 v128, v128
    v_mfma_f32_16x16x32_bf16 v[96:99], a[160:163], v[148:151], v[96:99]
    ds_read_b128 a[156:159], v173 offset:15360
    v_mfma_f32_16x16x32_bf16 v[100:103], a[164:167], v[148:151], v[100:103]
    v_exp_f32 v129, v129
    v_mfma_f32_16x16x32_bf16 v[104:107], a[168:171], v[148:151], v[104:107]
    ds_read_b128 a[96:99], v173 offset:16384
    v_cvt_pk_bf16_f32 v144, v128, v129
    v_mfma_f32_16x16x32_bf16 v[108:111], a[172:175], v[148:151], v[108:111]
    v_exp_f32 v130, v130
    v_mfma_f32_16x16x32_bf16 v[112:115], a[176:179], v[148:151], v[112:115]
    ds_read_b128 a[100:103], v173 offset:17408
    v_mfma_f32_16x16x32_bf16 v[116:119], a[180:183], v[148:151], v[116:119]
    v_exp_f32 v131, v131
    v_mfma_f32_16x16x32_bf16 v[120:123], a[184:187], v[148:151], v[120:123]
    ds_read_b128 a[104:107], v173 offset:18432
    v_cvt_pk_bf16_f32 v145, v130, v131
    v_mfma_f32_16x16x32_bf16 v[124:127], a[188:191], v[148:151], v[124:127]
    v_exp_f32 v132, v132
    v_mfma_f32_16x16x32_bf16 v[164:167], v[168:171], v[148:151], v[164:167]
    ds_read_b128 a[108:111], v173 offset:19456
    v_mfma_f32_16x16x32_bf16 v[136:139], a[64:67], a[16:19], 0
    v_exp_f32 v133, v133
    v_mfma_f32_16x16x32_bf16 v[136:139], a[68:71], a[20:23], v[136:139]
    ds_read_b128 a[112:115], v173 offset:20480
    v_cvt_pk_bf16_f32 v146, v132, v133
    v_mfma_f32_16x16x32_bf16 v[136:139], a[72:75], a[24:27], v[136:139]
    v_exp_f32 v134, v134
    v_mfma_f32_16x16x32_bf16 v[136:139], a[76:79], a[28:31], v[136:139]
    ds_read_b128 a[116:119], v173 offset:21504
    v_mfma_f32_16x16x32_bf16 v[140:143], a[80:83], a[16:19], 0
    v_exp_f32 v135, v135
    v_mfma_f32_16x16x32_bf16 v[140:143], a[84:87], a[20:23], v[140:143]
    ds_read_b128 a[120:123], v173 offset:22528
    v_cvt_pk_bf16_f32 v147, v134, v135
    v_mfma_f32_16x16x32_bf16 v[140:143], a[88:91], a[24:27], v[140:143]
    v_mfma_f32_16x16x32_bf16 v[140:143], a[92:95], a[28:31], v[140:143]
    v_exp_f32 v136, v136
    v_mfma_f32_16x16x32_bf16 v[0:3], a[128:131], v[144:147], v[0:3]
    ds_read_b128 a[124:127], v173 offset:23552
    v_mfma_f32_16x16x32_bf16 v[4:7], a[132:135], v[144:147], v[4:7]
    v_exp_f32 v137, v137
    v_mfma_f32_16x16x32_bf16 v[8:11], a[136:139], v[144:147], v[8:11]
    ds_read_b128 a[160:163], v173 offset:24576
    v_cvt_pk_bf16_f32 v148, v136, v137
    s_waitcnt lgkmcnt(3)
    v_mfma_f32_16x16x32_bf16 v[12:15], a[140:143], v[144:147], v[12:15]
    v_exp_f32 v138, v138
    v_mfma_f32_16x16x32_bf16 v[16:19], a[144:147], v[144:147], v[16:19]
    ds_read_b128 a[164:167], v173 offset:25600
    v_mfma_f32_16x16x32_bf16 v[20:23], a[148:151], v[144:147], v[20:23]
    v_exp_f32 v139, v139
    v_mfma_f32_16x16x32_bf16 v[24:27], a[152:155], v[144:147], v[24:27]
    ds_read_b128 a[168:171], v173 offset:26624
    v_cvt_pk_bf16_f32 v149, v138, v139
    v_mfma_f32_16x16x32_bf16 v[28:31], a[156:159], v[144:147], v[28:31]
    v_exp_f32 v140, v140
    v_mfma_f32_16x16x32_bf16 v[152:155], v[168:171], v[144:147], v[152:155]
    ds_read_b128 a[172:175], v173 offset:27648
    v_mfma_f32_16x16x32_bf16 v[128:131], a[96:99], a[0:3], 0
    v_exp_f32 v141, v141
    v_mfma_f32_16x16x32_bf16 v[128:131], a[100:103], a[4:7], v[128:131]
    ds_read_b128 a[176:179], v173 offset:28672
    v_cvt_pk_bf16_f32 v150, v140, v141
    v_mfma_f32_16x16x32_bf16 v[128:131], a[104:107], a[8:11], v[128:131]
    v_exp_f32 v142, v142
    v_mfma_f32_16x16x32_bf16 v[128:131], a[108:111], a[12:15], v[128:131]
    ds_read_b128 a[180:183], v173 offset:29696
    v_mfma_f32_16x16x32_bf16 v[132:135], a[112:115], a[0:3], 0
    v_exp_f32 v143, v143
    v_mfma_f32_16x16x32_bf16 v[132:135], a[116:119], a[4:7], v[132:135]
    ds_read_b128 a[184:187], v173 offset:30720
    v_cvt_pk_bf16_f32 v151, v142, v143
    s_waitcnt lgkmcnt(3)
    v_mfma_f32_16x16x32_bf16 v[132:135], a[120:123], a[8:11], v[132:135]
    v_mfma_f32_16x16x32_bf16 v[132:135], a[124:127], a[12:15], v[132:135]
    v_exp_f32 v128, v128
    v_mfma_f32_16x16x32_bf16 v[32:35], a[128:131], v[148:151], v[32:35]
    ds_read_b128 a[188:191], v173 offset:31744
    v_mfma_f32_16x16x32_bf16 v[36:39], a[132:135], v[148:151], v[36:39]
    v_exp_f32 v129, v129
    v_mfma_f32_16x16x32_bf16 v[40:43], a[136:139], v[148:151], v[40:43]
    ds_read_b128 a[64:67], v173 offset:32768
    v_cvt_pk_bf16_f32 v144, v128, v129
    v_mfma_f32_16x16x32_bf16 v[44:47], a[140:143], v[148:151], v[44:47]
    v_exp_f32 v130, v130
    v_mfma_f32_16x16x32_bf16 v[48:51], a[144:147], v[148:151], v[48:51]
    ds_read_b128 a[68:71], v173 offset:33792
    v_mfma_f32_16x16x32_bf16 v[52:55], a[148:151], v[148:151], v[52:55]
    v_exp_f32 v131, v131
    v_mfma_f32_16x16x32_bf16 v[56:59], a[152:155], v[148:151], v[56:59]
    ds_read_b128 a[72:75], v173 offset:34816
    v_cvt_pk_bf16_f32 v145, v130, v131
    v_mfma_f32_16x16x32_bf16 v[60:63], a[156:159], v[148:151], v[60:63]
    v_exp_f32 v132, v132
    v_mfma_f32_16x16x32_bf16 v[156:159], v[168:171], v[148:151], v[156:159]
    ds_read_b128 a[76:79], v173 offset:35840
    v_mfma_f32_16x16x32_bf16 v[136:139], a[96:99], a[16:19], 0
    v_exp_f32 v133, v133
    v_mfma_f32_16x16x32_bf16 v[136:139], a[100:103], a[20:23], v[136:139]
    ds_read_b128 a[80:83], v173 offset:36864
    v_cvt_pk_bf16_f32 v146, v132, v133
    v_mfma_f32_16x16x32_bf16 v[136:139], a[104:107], a[24:27], v[136:139]
    v_exp_f32 v134, v134
    v_mfma_f32_16x16x32_bf16 v[136:139], a[108:111], a[28:31], v[136:139]
    ds_read_b128 a[84:87], v173 offset:37888
    v_mfma_f32_16x16x32_bf16 v[140:143], a[112:115], a[16:19], 0
    v_exp_f32 v135, v135
    v_mfma_f32_16x16x32_bf16 v[140:143], a[116:119], a[20:23], v[140:143]
    ds_read_b128 a[88:91], v173 offset:38912
    v_cvt_pk_bf16_f32 v147, v134, v135
    v_mfma_f32_16x16x32_bf16 v[140:143], a[120:123], a[24:27], v[140:143]
    v_mfma_f32_16x16x32_bf16 v[140:143], a[124:127], a[28:31], v[140:143]
    v_exp_f32 v136, v136
    v_mfma_f32_16x16x32_bf16 v[0:3], a[160:163], v[144:147], v[0:3]
    ds_read_b128 a[92:95], v173 offset:39936
    v_mfma_f32_16x16x32_bf16 v[4:7], a[164:167], v[144:147], v[4:7]
    v_exp_f32 v137, v137
    v_mfma_f32_16x16x32_bf16 v[8:11], a[168:171], v[144:147], v[8:11]
    ds_read_b128 a[128:131], v173 offset:40960
    v_cvt_pk_bf16_f32 v148, v136, v137
    v_mfma_f32_16x16x32_bf16 v[12:15], a[172:175], v[144:147], v[12:15]
    v_exp_f32 v138, v138
    s_waitcnt lgkmcnt(2)
    v_mfma_f32_16x16x32_bf16 v[16:19], a[176:179], v[144:147], v[16:19]
    ds_read_b128 a[132:135], v173 offset:41984
    v_mfma_f32_16x16x32_bf16 v[20:23], a[180:183], v[144:147], v[20:23]
    v_exp_f32 v139, v139
    v_mfma_f32_16x16x32_bf16 v[24:27], a[184:187], v[144:147], v[24:27]
    ds_read_b128 a[136:139], v173 offset:43008
    v_cvt_pk_bf16_f32 v149, v138, v139
    v_mfma_f32_16x16x32_bf16 v[28:31], a[188:191], v[144:147], v[28:31]
    v_exp_f32 v140, v140
    v_mfma_f32_16x16x32_bf16 v[152:155], v[168:171], v[144:147], v[152:155]
    ds_read_b128 a[140:143], v173 offset:44032
    v_mfma_f32_16x16x32_bf16 v[128:131], a[64:67], a[0:3], 0
    v_exp_f32 v141, v141
    v_mfma_f32_16x16x32_bf16 v[128:131], a[68:71], a[4:7], v[128:131]
    ds_read_b128 a[144:147], v173 offset:45056
    v_cvt_pk_bf16_f32 v150, v140, v141
    v_mfma_f32_16x16x32_bf16 v[128:131], a[72:75], a[8:11], v[128:131]
    v_exp_f32 v142, v142
    v_mfma_f32_16x16x32_bf16 v[128:131], a[76:79], a[12:15], v[128:131]
    ds_read_b128 a[148:151], v173 offset:46080
    v_mfma_f32_16x16x32_bf16 v[132:135], a[80:83], a[0:3], 0
    v_exp_f32 v143, v143
    v_mfma_f32_16x16x32_bf16 v[132:135], a[84:87], a[4:7], v[132:135]
    ds_read_b128 a[152:155], v173 offset:47104
    v_cvt_pk_bf16_f32 v151, v142, v143
    v_mfma_f32_16x16x32_bf16 v[132:135], a[88:91], a[8:11], v[132:135]
    s_waitcnt lgkmcnt(3)
    v_mfma_f32_16x16x32_bf16 v[132:135], a[92:95], a[12:15], v[132:135]
    v_exp_f32 v128, v128
    v_mfma_f32_16x16x32_bf16 v[32:35], a[160:163], v[148:151], v[32:35]
    ds_read_b128 a[156:159], v173 offset:48128
    v_mfma_f32_16x16x32_bf16 v[36:39], a[164:167], v[148:151], v[36:39]
    v_exp_f32 v129, v129
    v_mfma_f32_16x16x32_bf16 v[40:43], a[168:171], v[148:151], v[40:43]
    ds_read_b128 a[96:99], v173 offset:49152
    v_cvt_pk_bf16_f32 v144, v128, v129
    v_mfma_f32_16x16x32_bf16 v[44:47], a[172:175], v[148:151], v[44:47]
    v_exp_f32 v130, v130
    v_mfma_f32_16x16x32_bf16 v[48:51], a[176:179], v[148:151], v[48:51]
    ds_read_b128 a[100:103], v173 offset:50176
    v_mfma_f32_16x16x32_bf16 v[52:55], a[180:183], v[148:151], v[52:55]
    v_exp_f32 v131, v131
    v_mfma_f32_16x16x32_bf16 v[56:59], a[184:187], v[148:151], v[56:59]
    ds_read_b128 a[104:107], v173 offset:51200
    v_cvt_pk_bf16_f32 v145, v130, v131
    v_mfma_f32_16x16x32_bf16 v[60:63], a[188:191], v[148:151], v[60:63]
    v_exp_f32 v132, v132
    v_mfma_f32_16x16x32_bf16 v[156:159], v[168:171], v[148:151], v[156:159]
    ds_read_b128 a[108:111], v173 offset:52224
    v_mfma_f32_16x16x32_bf16 v[136:139], a[64:67], a[16:19], 0
    v_exp_f32 v133, v133
    v_mfma_f32_16x16x32_bf16 v[136:139], a[68:71], a[20:23], v[136:139]
    ds_read_b128 a[112:115], v173 offset:53248
    v_cvt_pk_bf16_f32 v146, v132, v133
    v_mfma_f32_16x16x32_bf16 v[136:139], a[72:75], a[24:27], v[136:139]
    v_exp_f32 v134, v134
    v_mfma_f32_16x16x32_bf16 v[136:139], a[76:79], a[28:31], v[136:139]
    ds_read_b128 a[116:119], v173 offset:54272
    v_mfma_f32_16x16x32_bf16 v[140:143], a[80:83], a[16:19], 0
    v_exp_f32 v135, v135
    v_mfma_f32_16x16x32_bf16 v[140:143], a[84:87], a[20:23], v[140:143]
    ds_read_b128 a[120:123], v173 offset:55296
    v_cvt_pk_bf16_f32 v147, v134, v135
    v_mfma_f32_16x16x32_bf16 v[140:143], a[88:91], a[24:27], v[140:143]
    v_mfma_f32_16x16x32_bf16 v[140:143], a[92:95], a[28:31], v[140:143]
    v_exp_f32 v136, v136
    v_mfma_f32_16x16x32_bf16 v[0:3], a[128:131], v[144:147], v[0:3]
    ds_read_b128 a[124:127], v173 offset:56320
    v_mfma_f32_16x16x32_bf16 v[4:7], a[132:135], v[144:147], v[4:7]
    v_exp_f32 v137, v137
    v_mfma_f32_16x16x32_bf16 v[8:11], a[136:139], v[144:147], v[8:11]
    ds_read_b128 a[160:163], v173 offset:57344
    v_cvt_pk_bf16_f32 v148, v136, v137
    v_mfma_f32_16x16x32_bf16 v[12:15], a[140:143], v[144:147], v[12:15]
    v_exp_f32 v138, v138
    s_waitcnt lgkmcnt(2)
    v_mfma_f32_16x16x32_bf16 v[16:19], a[144:147], v[144:147], v[16:19]
    ds_read_b128 a[164:167], v173 offset:58368
    v_mfma_f32_16x16x32_bf16 v[20:23], a[148:151], v[144:147], v[20:23]
    v_exp_f32 v139, v139
    v_mfma_f32_16x16x32_bf16 v[24:27], a[152:155], v[144:147], v[24:27]
    ds_read_b128 a[168:171], v173 offset:59392
    v_cvt_pk_bf16_f32 v149, v138, v139
    v_mfma_f32_16x16x32_bf16 v[28:31], a[156:159], v[144:147], v[28:31]
    v_exp_f32 v140, v140
    v_mfma_f32_16x16x32_bf16 v[152:155], v[168:171], v[144:147], v[152:155]
    ds_read_b128 a[172:175], v173 offset:60416
    v_mfma_f32_16x16x32_bf16 v[128:131], a[96:99], a[0:3], 0
    v_exp_f32 v141, v141
    v_mfma_f32_16x16x32_bf16 v[128:131], a[100:103], a[4:7], v[128:131]
    ds_read_b128 a[176:179], v173 offset:61440
    v_cvt_pk_bf16_f32 v150, v140, v141
    v_mfma_f32_16x16x32_bf16 v[128:131], a[104:107], a[8:11], v[128:131]
    v_exp_f32 v142, v142
    v_mfma_f32_16x16x32_bf16 v[128:131], a[108:111], a[12:15], v[128:131]
    ds_read_b128 a[180:183], v173 offset:62464
    v_mfma_f32_16x16x32_bf16 v[132:135], a[112:115], a[0:3], 0
    v_exp_f32 v143, v143
    v_mfma_f32_16x16x32_bf16 v[132:135], a[116:119], a[4:7], v[132:135]
    ds_read_b128 a[184:187], v173 offset:63488
    v_cvt_pk_bf16_f32 v151, v142, v143
    v_mfma_f32_16x16x32_bf16 v[132:135], a[120:123], a[8:11], v[132:135]
    s_waitcnt lgkmcnt(3)
    v_mfma_f32_16x16x32_bf16 v[132:135], a[124:127], a[12:15], v[132:135]
    v_exp_f32 v128, v128
    v_mfma_f32_16x16x32_bf16 v[32:35], a[128:131], v[148:151], v[32:35]
    ds_read_b128 a[188:191], v173 offset:64512
    v_mfma_f32_16x16x32_bf16 v[36:39], a[132:135], v[148:151], v[36:39]
    v_exp_f32 v129, v129
    v_mfma_f32_16x16x32_bf16 v[40:43], a[136:139], v[148:151], v[40:43]
    ds_read_b128 a[64:67], v173
    v_cvt_pk_bf16_f32 v144, v128, v129
    v_mfma_f32_16x16x32_bf16 v[44:47], a[140:143], v[148:151], v[44:47]
    v_exp_f32 v130, v130
    v_mfma_f32_16x16x32_bf16 v[48:51], a[144:147], v[148:151], v[48:51]
    ds_read_b128 a[68:71], v173 offset:1024
    v_mfma_f32_16x16x32_bf16 v[52:55], a[148:151], v[148:151], v[52:55]
    v_exp_f32 v131, v131
    v_mfma_f32_16x16x32_bf16 v[56:59], a[152:155], v[148:151], v[56:59]
    ds_read_b128 a[72:75], v173 offset:2048
    v_cvt_pk_bf16_f32 v145, v130, v131
    v_mfma_f32_16x16x32_bf16 v[60:63], a[156:159], v[148:151], v[60:63]
    v_exp_f32 v132, v132
    v_mfma_f32_16x16x32_bf16 v[156:159], v[168:171], v[148:151], v[156:159]
    ds_read_b128 a[76:79], v173 offset:3072
    v_mfma_f32_16x16x32_bf16 v[136:139], a[96:99], a[16:19], 0
    v_exp_f32 v133, v133
    v_mfma_f32_16x16x32_bf16 v[136:139], a[100:103], a[20:23], v[136:139]
    ds_read_b128 a[80:83], v173 offset:4096
    v_cvt_pk_bf16_f32 v146, v132, v133
    v_mfma_f32_16x16x32_bf16 v[136:139], a[104:107], a[24:27], v[136:139]
    v_exp_f32 v134, v134
    v_mfma_f32_16x16x32_bf16 v[136:139], a[108:111], a[28:31], v[136:139]
    ds_read_b128 a[84:87], v173 offset:5120
    v_mfma_f32_16x16x32_bf16 v[140:143], a[112:115], a[16:19], 0
    v_exp_f32 v135, v135
    v_mfma_f32_16x16x32_bf16 v[140:143], a[116:119], a[20:23], v[140:143]
    ds_read_b128 a[88:91], v173 offset:6144
    v_cvt_pk_bf16_f32 v147, v134, v135
    v_mfma_f32_16x16x32_bf16 v[140:143], a[120:123], a[24:27], v[140:143]
    v_mfma_f32_16x16x32_bf16 v[140:143], a[124:127], a[28:31], v[140:143]
    v_exp_f32 v136, v136
    v_mfma_f32_16x16x32_bf16 v[0:3], a[160:163], v[144:147], v[0:3]
    ds_read_b128 a[92:95], v173 offset:7168
    v_mfma_f32_16x16x32_bf16 v[4:7], a[164:167], v[144:147], v[4:7]
    v_exp_f32 v137, v137
    v_mfma_f32_16x16x32_bf16 v[8:11], a[168:171], v[144:147], v[8:11]
    ds_read_b128 a[128:131], v173 offset:8192
    v_cvt_pk_bf16_f32 v148, v136, v137
    v_mfma_f32_16x16x32_bf16 v[12:15], a[172:175], v[144:147], v[12:15]
    v_exp_f32 v138, v138
    s_waitcnt lgkmcnt(2)
    v_mfma_f32_16x16x32_bf16 v[16:19], a[176:179], v[144:147], v[16:19]
    ds_read_b128 a[132:135], v173 offset:9216
    v_mfma_f32_16x16x32_bf16 v[20:23], a[180:183], v[144:147], v[20:23]
    v_exp_f32 v139, v139
    v_mfma_f32_16x16x32_bf16 v[24:27], a[184:187], v[144:147], v[24:27]
    ds_read_b128 a[136:139], v173 offset:10240
    v_cvt_pk_bf16_f32 v149, v138, v139
    v_mfma_f32_16x16x32_bf16 v[28:31], a[188:191], v[144:147], v[28:31]
    v_exp_f32 v140, v140
    v_mfma_f32_16x16x32_bf16 v[152:155], v[168:171], v[144:147], v[152:155]
    ds_read_b128 a[140:143], v173 offset:11264
    v_mfma_f32_16x16x32_bf16 v[128:131], a[64:67], a[32:35], 0
    v_exp_f32 v141, v141
    v_mfma_f32_16x16x32_bf16 v[128:131], a[68:71], a[36:39], v[128:131]
    ds_read_b128 a[144:147], v173 offset:12288
    v_cvt_pk_bf16_f32 v150, v140, v141
    v_mfma_f32_16x16x32_bf16 v[128:131], a[72:75], a[40:43], v[128:131]
    v_exp_f32 v142, v142
    v_mov_b32 v217, v152
    v_mfma_f32_16x16x32_bf16 v[128:131], a[76:79], a[44:47], v[128:131]
    ds_read_b128 a[148:151], v173 offset:13312
    v_mov_b32 v218, v152
    v_mfma_f32_16x16x32_bf16 v[132:135], a[80:83], a[32:35], 0
    v_exp_f32 v143, v143
    v_mfma_f32_16x16x32_bf16 v[132:135], a[84:87], a[36:39], v[132:135]
    ds_read_b128 a[152:155], v173 offset:14336
    v_cvt_pk_bf16_f32 v151, v142, v143
    v_mfma_f32_16x16x32_bf16 v[132:135], a[88:91], a[40:43], v[132:135]
    v_rcp_f32 v152, v152
    s_waitcnt lgkmcnt(3)
    v_mfma_f32_16x16x32_bf16 v[132:135], a[92:95], a[44:47], v[132:135]
    v_exp_f32 v128, v128
    v_mul_f32 v0, v0, v152
    v_mfma_f32_16x16x32_bf16 v[32:35], a[160:163], v[148:151], v[32:35]
    ds_read_b128 a[156:159], v173 offset:15360
    v_mul_f32 v4, v4, v152
    v_mul_f32 v1, v1, v152
    v_mfma_f32_16x16x32_bf16 v[36:39], a[164:167], v[148:151], v[36:39]
    v_exp_f32 v129, v129
    v_mul_f32 v5, v5, v152
    v_mfma_f32_16x16x32_bf16 v[40:43], a[168:171], v[148:151], v[40:43]
    ds_read_b128 a[96:99], v173 offset:16384
    v_cvt_pk_bf16_f32 v144, v128, v129
    v_mul_f32 v2, v2, v152
    v_mfma_f32_16x16x32_bf16 v[44:47], a[172:175], v[148:151], v[44:47]
    v_exp_f32 v130, v130
    v_mul_f32 v6, v6, v152
    v_mfma_f32_16x16x32_bf16 v[48:51], a[176:179], v[148:151], v[48:51]
    ds_read_b128 a[100:103], v173 offset:17408
    v_mul_f32 v3, v3, v152
    v_mul_f32 v7, v7, v152
    v_mfma_f32_16x16x32_bf16 v[52:55], a[180:183], v[148:151], v[52:55]
    v_exp_f32 v131, v131
    v_cvt_pk_bf16_f32 v180, v0, v1
    v_mfma_f32_16x16x32_bf16 v[56:59], a[184:187], v[148:151], v[56:59]
    ds_read_b128 a[104:107], v173 offset:18432
    v_cvt_pk_bf16_f32 v145, v130, v131
    v_cvt_pk_bf16_f32 v181, v2, v3
    v_mfma_f32_16x16x32_bf16 v[60:63], a[188:191], v[148:151], v[60:63]
    v_exp_f32 v132, v132
    v_cvt_pk_bf16_f32 v182, v4, v5
    v_mfma_f32_16x16x32_bf16 v[156:159], v[168:171], v[148:151], v[156:159]
    ds_read_b128 a[108:111], v173 offset:19456
    v_cvt_pk_bf16_f32 v183, v6, v7
    v_mfma_f32_16x16x32_bf16 v[136:139], a[64:67], a[48:51], 0
    v_exp_f32 v133, v133
    v_mfma_f32_16x16x32_bf16 v[136:139], a[68:71], a[52:55], v[136:139]
    ds_read_b128 a[112:115], v173 offset:20480
    v_cvt_pk_bf16_f32 v146, v132, v133
    v_permlane16_swap_b32 v180, v182
    v_mfma_f32_16x16x32_bf16 v[136:139], a[72:75], a[56:59], v[136:139]
    v_exp_f32 v134, v134
    v_permlane16_swap_b32 v181, v183
    v_mfma_f32_16x16x32_bf16 v[136:139], a[76:79], a[60:63], v[136:139]
    ds_read_b128 a[116:119], v173 offset:21504
    v_mfma_f32_16x16x32_bf16 v[140:143], a[80:83], a[48:51], 0
    buffer_store_dwordx4 v[180:183], v216, s[8:11], s90 offen sc0 sc1
    v_exp_f32 v135, v135
    v_mfma_f32_16x16x32_bf16 v[140:143], a[84:87], a[52:55], v[140:143]
    ds_read_b128 a[120:123], v173 offset:22528
    v_cvt_pk_bf16_f32 v147, v134, v135
    v_mul_f32 v8, v8, v152
    v_mfma_f32_16x16x32_bf16 v[140:143], a[88:91], a[56:59], v[140:143]
    v_mul_f32 v12, v12, v152
    v_mul_f32 v9, v9, v152
    v_mul_f32 v13, v13, v152
    v_mfma_f32_16x16x32_bf16 v[140:143], a[92:95], a[60:63], v[140:143]
    v_exp_f32 v136, v136
    v_mul_f32 v10, v10, v152
    v_mfma_f32_16x16x32_bf16 v[64:67], a[128:131], v[144:147], v[64:67]
    ds_read_b128 a[124:127], v173 offset:23552
    v_mul_f32 v14, v14, v152
    v_mul_f32 v11, v11, v152
    v_mfma_f32_16x16x32_bf16 v[68:71], a[132:135], v[144:147], v[68:71]
    v_exp_f32 v137, v137
    v_mul_f32 v15, v15, v152
    v_mfma_f32_16x16x32_bf16 v[72:75], a[136:139], v[144:147], v[72:75]
    ds_read_b128 a[160:163], v173 offset:24576
    v_cvt_pk_bf16_f32 v148, v136, v137
    v_cvt_pk_bf16_f32 v184, v8, v9
    v_mfma_f32_16x16x32_bf16 v[76:79], a[140:143], v[144:147], v[76:79]
    v_exp_f32 v138, v138
    v_cvt_pk_bf16_f32 v185, v10, v11
    s_waitcnt lgkmcnt(2)
    v_mfma_f32_16x16x32_bf16 v[80:83], a[144:147], v[144:147], v[80:83]
    ds_read_b128 a[164:167], v173 offset:25600
    v_cvt_pk_bf16_f32 v186, v12, v13
    v_cvt_pk_bf16_f32 v187, v14, v15
    v_mfma_f32_16x16x32_bf16 v[84:87], a[148:151], v[144:147], v[84:87]
    v_exp_f32 v139, v139
    v_mfma_f32_16x16x32_bf16 v[88:91], a[152:155], v[144:147], v[88:91]
    ds_read_b128 a[168:171], v173 offset:26624
    v_cvt_pk_bf16_f32 v149, v138, v139
    v_permlane16_swap_b32 v184, v186
    v_mfma_f32_16x16x32_bf16 v[92:95], a[156:159], v[144:147], v[92:95]
    v_exp_f32 v140, v140
    v_permlane16_swap_b32 v185, v187
    v_mfma_f32_16x16x32_bf16 v[160:163], v[168:171], v[144:147], v[160:163]
    ds_read_b128 a[172:175], v173 offset:27648
    v_mfma_f32_16x16x32_bf16 v[128:131], a[96:99], a[32:35], 0
    buffer_store_dwordx4 v[184:187], v216, s[8:11], s90 offen offset:64 sc0 sc1
    v_exp_f32 v141, v141
    v_mfma_f32_16x16x32_bf16 v[128:131], a[100:103], a[36:39], v[128:131]
    ds_read_b128 a[176:179], v173 offset:28672
    v_cvt_pk_bf16_f32 v150, v140, v141
    v_mul_f32 v16, v16, v152
    v_mfma_f32_16x16x32_bf16 v[128:131], a[104:107], a[40:43], v[128:131]
    v_exp_f32 v142, v142
    v_mul_f32 v20, v20, v152
    v_mfma_f32_16x16x32_bf16 v[128:131], a[108:111], a[44:47], v[128:131]
    ds_read_b128 a[180:183], v173 offset:29696
    v_mul_f32 v17, v17, v152
    v_mul_f32 v21, v21, v152
    v_mfma_f32_16x16x32_bf16 v[132:135], a[112:115], a[32:35], 0
    v_exp_f32 v143, v143
    v_mul_f32 v18, v18, v152
    v_mfma_f32_16x16x32_bf16 v[132:135], a[116:119], a[36:39], v[132:135]
    ds_read_b128 a[184:187], v173 offset:30720
    v_cvt_pk_bf16_f32 v151, v142, v143
    v_mul_f32 v22, v22, v152
    v_mfma_f32_16x16x32_bf16 v[132:135], a[120:123], a[40:43], v[132:135]
    v_mul_f32 v19, v19, v152
    v_mul_f32 v23, v23, v152
    v_cvt_pk_bf16_f32 v188, v16, v17
    s_waitcnt lgkmcnt(3)
    v_mfma_f32_16x16x32_bf16 v[132:135], a[124:127], a[44:47], v[132:135]
    v_exp_f32 v128, v128
    v_cvt_pk_bf16_f32 v189, v18, v19
    v_mfma_f32_16x16x32_bf16 v[96:99], a[128:131], v[148:151], v[96:99]
    ds_read_b128 a[188:191], v173 offset:31744
    v_cvt_pk_bf16_f32 v190, v20, v21
    v_cvt_pk_bf16_f32 v191, v22, v23
    v_mfma_f32_16x16x32_bf16 v[100:103], a[132:135], v[148:151], v[100:103]
    v_exp_f32 v129, v129
    v_mfma_f32_16x16x32_bf16 v[104:107], a[136:139], v[148:151], v[104:107]
    ds_read_b128 a[64:67], v173 offset:32768
    v_cvt_pk_bf16_f32 v144, v128, v129
    v_permlane16_swap_b32 v188, v190
    v_mfma_f32_16x16x32_bf16 v[108:111], a[140:143], v[148:151], v[108:111]
    v_exp_f32 v130, v130
    v_permlane16_swap_b32 v189, v191
    v_mfma_f32_16x16x32_bf16 v[112:115], a[144:147], v[148:151], v[112:115]
    ds_read_b128 a[68:71], v173 offset:33792
    v_mfma_f32_16x16x32_bf16 v[116:119], a[148:151], v[148:151], v[116:119]
    buffer_store_dwordx4 v[188:191], v216, s[8:11], s90 offen offset:128 sc0 sc1
    v_exp_f32 v131, v131
    v_mfma_f32_16x16x32_bf16 v[120:123], a[152:155], v[148:151], v[120:123]
    ds_read_b128 a[72:75], v173 offset:34816
    v_cvt_pk_bf16_f32 v145, v130, v131
    v_mul_f32 v24, v24, v152
    v_mfma_f32_16x16x32_bf16 v[124:127], a[156:159], v[148:151], v[124:127]
    v_exp_f32 v132, v132
    v_mul_f32 v28, v28, v152
    v_mfma_f32_16x16x32_bf16 v[164:167], v[168:171], v[148:151], v[164:167]
    ds_read_b128 a[76:79], v173 offset:35840
    v_mul_f32 v25, v25, v152
    v_mul_f32 v29, v29, v152
    v_mfma_f32_16x16x32_bf16 v[136:139], a[96:99], a[48:51], 0
    v_exp_f32 v133, v133
    v_mul_f32 v26, v26, v152
    v_mfma_f32_16x16x32_bf16 v[136:139], a[100:103], a[52:55], v[136:139]
    ds_read_b128 a[80:83], v173 offset:36864
    v_cvt_pk_bf16_f32 v146, v132, v133
    v_mul_f32 v30, v30, v152
    v_mfma_f32_16x16x32_bf16 v[136:139], a[104:107], a[56:59], v[136:139]
    v_exp_f32 v134, v134
    v_mul_f32 v27, v27, v152
    v_mfma_f32_16x16x32_bf16 v[136:139], a[108:111], a[60:63], v[136:139]
    ds_read_b128 a[84:87], v173 offset:37888
    v_mul_f32 v31, v31, v152
    v_cvt_pk_bf16_f32 v192, v24, v25
    v_mfma_f32_16x16x32_bf16 v[140:143], a[112:115], a[48:51], 0
    v_exp_f32 v135, v135
    v_cvt_pk_bf16_f32 v193, v26, v27
    v_mfma_f32_16x16x32_bf16 v[140:143], a[116:119], a[52:55], v[140:143]
    ds_read_b128 a[88:91], v173 offset:38912
    v_cvt_pk_bf16_f32 v147, v134, v135
    v_cvt_pk_bf16_f32 v194, v28, v29
    v_mfma_f32_16x16x32_bf16 v[140:143], a[120:123], a[56:59], v[140:143]
    v_cvt_pk_bf16_f32 v195, v30, v31
    v_mfma_f32_16x16x32_bf16 v[140:143], a[124:127], a[60:63], v[140:143]
    v_exp_f32 v136, v136
    v_mfma_f32_16x16x32_bf16 v[64:67], a[160:163], v[144:147], v[64:67]
    ds_read_b128 a[92:95], v173 offset:39936
    v_permlane16_swap_b32 v192, v194
    v_permlane16_swap_b32 v193, v195
    v_mfma_f32_16x16x32_bf16 v[68:71], a[164:167], v[144:147], v[68:71]
    buffer_store_dwordx4 v[192:195], v216, s[8:11], s90 offen offset:192 sc0 sc1
    v_exp_f32 v137, v137
    v_mfma_f32_16x16x32_bf16 v[72:75], a[168:171], v[144:147], v[72:75]
    ds_read_b128 a[128:131], v173 offset:40960
    v_cvt_pk_bf16_f32 v148, v136, v137
    v_add_f32 v217, v217, v156
    s_add_u32 s90, s90, 0x1000
    v_mfma_f32_16x16x32_bf16 v[76:79], a[172:175], v[144:147], v[76:79]
    v_exp_f32 v138, v138
    v_min_f32 v218, v218, v156
    s_waitcnt lgkmcnt(2)
    v_mfma_f32_16x16x32_bf16 v[80:83], a[176:179], v[144:147], v[80:83]
    ds_read_b128 a[132:135], v173 offset:41984
    v_rcp_f32 v156, v156
    v_mfma_f32_16x16x32_bf16 v[84:87], a[180:183], v[144:147], v[84:87]
    v_exp_f32 v139, v139
    v_mul_f32 v32, v32, v156
    v_mfma_f32_16x16x32_bf16 v[88:91], a[184:187], v[144:147], v[88:91]
    ds_read_b128 a[136:139], v173 offset:43008
    v_cvt_pk_bf16_f32 v149, v138, v139
    v_mul_f32 v36, v36, v156
    v_mfma_f32_16x16x32_bf16 v[92:95], a[188:191], v[144:147], v[92:95]
    v_exp_f32 v140, v140
    v_mul_f32 v33, v33, v156
    v_mfma_f32_16x16x32_bf16 v[160:163], v[168:171], v[144:147], v[160:163]
    ds_read_b128 a[140:143], v173 offset:44032
    v_mul_f32 v37, v37, v156
    v_mul_f32 v34, v34, v156
    v_mfma_f32_16x16x32_bf16 v[128:131], a[64:67], a[32:35], 0
    v_exp_f32 v141, v141
    v_mul_f32 v38, v38, v156
    v_mfma_f32_16x16x32_bf16 v[128:131], a[68:71], a[36:39], v[128:131]
    ds_read_b128 a[144:147], v173 offset:45056
    v_cvt_pk_bf16_f32 v150, v140, v141
    v_mul_f32 v35, v35, v156
    v_mfma_f32_16x16x32_bf16 v[128:131], a[72:75], a[40:43], v[128:131]
    v_exp_f32 v142, v142
    v_mul_f32 v39, v39, v156
    v_mfma_f32_16x16x32_bf16 v[128:131], a[76:79], a[44:47], v[128:131]
    ds_read_b128 a[148:151], v173 offset:46080
    v_cvt_pk_bf16_f32 v196, v32, v33
    v_cvt_pk_bf16_f32 v197, v34, v35
    v_mfma_f32_16x16x32_bf16 v[132:135], a[80:83], a[32:35], 0
    v_exp_f32 v143, v143
    v_cvt_pk_bf16_f32 v198, v36, v37
    v_mfma_f32_16x16x32_bf16 v[132:135], a[84:87], a[36:39], v[132:135]
    ds_read_b128 a[152:155], v173 offset:47104
    v_cvt_pk_bf16_f32 v151, v142, v143
    v_cvt_pk_bf16_f32 v199, v38, v39
    v_mfma_f32_16x16x32_bf16 v[132:135], a[88:91], a[40:43], v[132:135]
    s_waitcnt lgkmcnt(3)
    v_mfma_f32_16x16x32_bf16 v[132:135], a[92:95], a[44:47], v[132:135]
    v_exp_f32 v128, v128
    v_permlane16_swap_b32 v196, v198
    v_mfma_f32_16x16x32_bf16 v[96:99], a[160:163], v[148:151], v[96:99]
    ds_read_b128 a[156:159], v173 offset:48128
    v_permlane16_swap_b32 v197, v199
    v_mfma_f32_16x16x32_bf16 v[100:103], a[164:167], v[148:151], v[100:103]
    buffer_store_dwordx4 v[196:199], v216, s[8:11], s90 offen sc0 sc1
    v_exp_f32 v129, v129
    v_mfma_f32_16x16x32_bf16 v[104:107], a[168:171], v[148:151], v[104:107]
    ds_read_b128 a[96:99], v173 offset:49152
    v_cvt_pk_bf16_f32 v144, v128, v129
    v_mul_f32 v40, v40, v156
    v_mfma_f32_16x16x32_bf16 v[108:111], a[172:175], v[148:151], v[108:111]
    v_exp_f32 v130, v130
    v_mul_f32 v44, v44, v156
    v_mfma_f32_16x16x32_bf16 v[112:115], a[176:179], v[148:151], v[112:115]
    ds_read_b128 a[100:103], v173 offset:50176
    v_mul_f32 v41, v41, v156
    v_mul_f32 v45, v45, v156
    v_mfma_f32_16x16x32_bf16 v[116:119], a[180:183], v[148:151], v[116:119]
    v_exp_f32 v131, v131
    v_mul_f32 v42, v42, v156
    v_mfma_f32_16x16x32_bf16 v[120:123], a[184:187], v[148:151], v[120:123]
    ds_read_b128 a[104:107], v173 offset:51200
    v_cvt_pk_bf16_f32 v145, v130, v131
    v_mul_f32 v46, v46, v156
    v_mfma_f32_16x16x32_bf16 v[124:127], a[188:191], v[148:151], v[124:127]
    v_exp_f32 v132, v132
    v_mul_f32 v43, v43, v156
    v_mfma_f32_16x16x32_bf16 v[164:167], v[168:171], v[148:151], v[164:167]
    ds_read_b128 a[108:111], v173 offset:52224
    v_mul_f32 v47, v47, v156
    v_cvt_pk_bf16_f32 v200, v40, v41
    v_mfma_f32_16x16x32_bf16 v[136:139], a[64:67], a[48:51], 0
    v_exp_f32 v133, v133
    v_cvt_pk_bf16_f32 v201, v42, v43
    v_mfma_f32_16x16x32_bf16 v[136:139], a[68:71], a[52:55], v[136:139]
    ds_read_b128 a[112:115], v173 offset:53248
    v_cvt_pk_bf16_f32 v146, v132, v133
    v_cvt_pk_bf16_f32 v202, v44, v45
    v_mfma_f32_16x16x32_bf16 v[136:139], a[72:75], a[56:59], v[136:139]
    v_exp_f32 v134, v134
    v_cvt_pk_bf16_f32 v203, v46, v47
    v_mfma_f32_16x16x32_bf16 v[136:139], a[76:79], a[60:63], v[136:139]
    ds_read_b128 a[116:119], v173 offset:54272
    v_mfma_f32_16x16x32_bf16 v[140:143], a[80:83], a[48:51], 0
    v_exp_f32 v135, v135
    v_permlane16_swap_b32 v200, v202
    v_mfma_f32_16x16x32_bf16 v[140:143], a[84:87], a[52:55], v[140:143]
    ds_read_b128 a[120:123], v173 offset:55296
    v_cvt_pk_bf16_f32 v147, v134, v135
    v_permlane16_swap_b32 v201, v203
    v_mfma_f32_16x16x32_bf16 v[140:143], a[88:91], a[56:59], v[140:143]
    buffer_store_dwordx4 v[200:203], v216, s[8:11], s90 offen offset:64 sc0 sc1
    v_mfma_f32_16x16x32_bf16 v[140:143], a[92:95], a[60:63], v[140:143]
    v_exp_f32 v136, v136
    v_mul_f32 v48, v48, v156
    v_mfma_f32_16x16x32_bf16 v[64:67], a[128:131], v[144:147], v[64:67]
    ds_read_b128 a[124:127], v173 offset:56320
    v_mul_f32 v52, v52, v156
    v_mul_f32 v49, v49, v156
    v_mfma_f32_16x16x32_bf16 v[68:71], a[132:135], v[144:147], v[68:71]
    v_exp_f32 v137, v137
    v_mul_f32 v53, v53, v156
    v_mfma_f32_16x16x32_bf16 v[72:75], a[136:139], v[144:147], v[72:75]
    ds_read_b128 a[160:163], v173 offset:57344
    v_cvt_pk_bf16_f32 v148, v136, v137
    v_mul_f32 v50, v50, v156
    v_mfma_f32_16x16x32_bf16 v[76:79], a[140:143], v[144:147], v[76:79]
    v_exp_f32 v138, v138
    v_mul_f32 v54, v54, v156
    s_waitcnt lgkmcnt(2)
    v_mfma_f32_16x16x32_bf16 v[80:83], a[144:147], v[144:147], v[80:83]
    ds_read_b128 a[164:167], v173 offset:58368
    v_mul_f32 v51, v51, v156
    v_mul_f32 v55, v55, v156
    v_mfma_f32_16x16x32_bf16 v[84:87], a[148:151], v[144:147], v[84:87]
    v_exp_f32 v139, v139
    v_cvt_pk_bf16_f32 v204, v48, v49
    v_mfma_f32_16x16x32_bf16 v[88:91], a[152:155], v[144:147], v[88:91]
    ds_read_b128 a[168:171], v173 offset:59392
    v_cvt_pk_bf16_f32 v149, v138, v139
    v_cvt_pk_bf16_f32 v205, v50, v51
    v_mfma_f32_16x16x32_bf16 v[92:95], a[156:159], v[144:147], v[92:95]
    v_exp_f32 v140, v140
    v_cvt_pk_bf16_f32 v206, v52, v53
    v_mfma_f32_16x16x32_bf16 v[160:163], v[168:171], v[144:147], v[160:163]
    ds_read_b128 a[172:175], v173 offset:60416
    v_cvt_pk_bf16_f32 v207, v54, v55
    v_mfma_f32_16x16x32_bf16 v[128:131], a[96:99], a[32:35], 0
    v_exp_f32 v141, v141
    v_mfma_f32_16x16x32_bf16 v[128:131], a[100:103], a[36:39], v[128:131]
    ds_read_b128 a[176:179], v173 offset:61440
    v_cvt_pk_bf16_f32 v150, v140, v141
    v_permlane16_swap_b32 v204, v206
    v_mfma_f32_16x16x32_bf16 v[128:131], a[104:107], a[40:43], v[128:131]
    v_exp_f32 v142, v142
    v_permlane16_swap_b32 v205, v207
    v_mfma_f32_16x16x32_bf16 v[128:131], a[108:111], a[44:47], v[128:131]
    ds_read_b128 a[180:183], v173 offset:62464
    v_mfma_f32_16x16x32_bf16 v[132:135], a[112:115], a[32:35], 0
    buffer_store_dwordx4 v[204:207], v216, s[8:11], s90 offen offset:128 sc0 sc1
    v_exp_f32 v143, v143
    v_mfma_f32_16x16x32_bf16 v[132:135], a[116:119], a[36:39], v[132:135]
    ds_read_b128 a[184:187], v173 offset:63488
    v_cvt_pk_bf16_f32 v151, v142, v143
    v_mul_f32 v56, v56, v156
    v_mfma_f32_16x16x32_bf16 v[132:135], a[120:123], a[40:43], v[132:135]
    v_mul_f32 v60, v60, v156
    v_mul_f32 v57, v57, v156
    v_mul_f32 v61, v61, v156
    s_waitcnt lgkmcnt(3)
    v_mfma_f32_16x16x32_bf16 v[132:135], a[124:127], a[44:47], v[132:135]
    v_exp_f32 v128, v128
    v_mul_f32 v58, v58, v156
    v_mfma_f32_16x16x32_bf16 v[96:99], a[128:131], v[148:151], v[96:99]
    ds_read_b128 a[188:191], v173 offset:64512
    v_mul_f32 v62, v62, v156
    v_mul_f32 v59, v59, v156
    v_mfma_f32_16x16x32_bf16 v[100:103], a[132:135], v[148:151], v[100:103]
    v_exp_f32 v129, v129
    v_mul_f32 v63, v63, v156
    v_mfma_f32_16x16x32_bf16 v[104:107], a[136:139], v[148:151], v[104:107]
    v_cvt_pk_bf16_f32 v144, v128, v129
    v_cvt_pk_bf16_f32 v208, v56, v57
    v_cvt_pk_bf16_f32 v209, v58, v59
    v_mfma_f32_16x16x32_bf16 v[108:111], a[140:143], v[148:151], v[108:111]
    v_exp_f32 v130, v130
    v_cvt_pk_bf16_f32 v210, v60, v61
    v_mfma_f32_16x16x32_bf16 v[112:115], a[144:147], v[148:151], v[112:115]
    v_cvt_pk_bf16_f32 v211, v62, v63
    v_mfma_f32_16x16x32_bf16 v[116:119], a[148:151], v[148:151], v[116:119]
    v_exp_f32 v131, v131
    v_mfma_f32_16x16x32_bf16 v[120:123], a[152:155], v[148:151], v[120:123]
    v_cvt_pk_bf16_f32 v145, v130, v131
    v_permlane16_swap_b32 v208, v210
    v_permlane16_swap_b32 v209, v211
    v_mfma_f32_16x16x32_bf16 v[124:127], a[156:159], v[148:151], v[124:127]
    buffer_store_dwordx4 v[208:211], v216, s[8:11], s90 offen offset:192 sc0 sc1
    v_exp_f32 v132, v132
    v_mfma_f32_16x16x32_bf16 v[164:167], v[168:171], v[148:151], v[164:167]
    s_add_u32 s90, s90, 0x1000
    v_mfma_f32_16x16x32_bf16 v[136:139], a[96:99], a[48:51], 0
    v_exp_f32 v133, v133
    v_mfma_f32_16x16x32_bf16 v[136:139], a[100:103], a[52:55], v[136:139]
    v_cvt_pk_bf16_f32 v146, v132, v133
    v_mfma_f32_16x16x32_bf16 v[136:139], a[104:107], a[56:59], v[136:139]
    v_exp_f32 v134, v134
    v_mfma_f32_16x16x32_bf16 v[136:139], a[108:111], a[60:63], v[136:139]
    v_mfma_f32_16x16x32_bf16 v[140:143], a[112:115], a[48:51], 0
    v_exp_f32 v135, v135
    v_mfma_f32_16x16x32_bf16 v[140:143], a[116:119], a[52:55], v[140:143]
    v_cvt_pk_bf16_f32 v147, v134, v135
    v_mfma_f32_16x16x32_bf16 v[140:143], a[120:123], a[56:59], v[140:143]
    v_mfma_f32_16x16x32_bf16 v[140:143], a[124:127], a[60:63], v[140:143]
    v_exp_f32 v136, v136
    v_mfma_f32_16x16x32_bf16 v[64:67], a[160:163], v[144:147], v[64:67]
    v_mfma_f32_16x16x32_bf16 v[68:71], a[164:167], v[144:147], v[68:71]
    v_exp_f32 v137, v137
    v_mfma_f32_16x16x32_bf16 v[72:75], a[168:171], v[144:147], v[72:75]
    v_cvt_pk_bf16_f32 v148, v136, v137
    v_mfma_f32_16x16x32_bf16 v[76:79], a[172:175], v[144:147], v[76:79]
    v_exp_f32 v138, v138
    s_waitcnt lgkmcnt(0)
    v_mfma_f32_16x16x32_bf16 v[80:83], a[176:179], v[144:147], v[80:83]
    v_mfma_f32_16x16x32_bf16 v[84:87], a[180:183], v[144:147], v[84:87]
    v_exp_f32 v139, v139
    v_mfma_f32_16x16x32_bf16 v[88:91], a[184:187], v[144:147], v[88:91]
    v_cvt_pk_bf16_f32 v149, v138, v139
    v_mfma_f32_16x16x32_bf16 v[92:95], a[188:191], v[144:147], v[92:95]
    v_exp_f32 v140, v140
    v_mfma_f32_16x16x32_bf16 v[160:163], v[168:171], v[144:147], v[160:163]
    v_exp_f32 v141, v141
    s_nop 0
    v_cvt_pk_bf16_f32 v150, v140, v141
    s_nop 0
    v_exp_f32 v142, v142
    s_nop 0
    v_exp_f32 v143, v143
    s_nop 0
    v_cvt_pk_bf16_f32 v151, v142, v143
    s_nop 0
    s_waitcnt lgkmcnt(0)
    s_nop 1
    v_mfma_f32_16x16x32_bf16 v[96:99], a[160:163], v[148:151], v[96:99]
    v_mfma_f32_16x16x32_bf16 v[100:103], a[164:167], v[148:151], v[100:103]
    v_mfma_f32_16x16x32_bf16 v[104:107], a[168:171], v[148:151], v[104:107]
    v_mfma_f32_16x16x32_bf16 v[108:111], a[172:175], v[148:151], v[108:111]
    v_mfma_f32_16x16x32_bf16 v[112:115], a[176:179], v[148:151], v[112:115]
    v_mfma_f32_16x16x32_bf16 v[116:119], a[180:183], v[148:151], v[116:119]
    v_mfma_f32_16x16x32_bf16 v[120:123], a[184:187], v[148:151], v[120:123]
    v_mfma_f32_16x16x32_bf16 v[124:127], a[188:191], v[148:151], v[124:127]
    v_mfma_f32_16x16x32_bf16 v[164:167], v[168:171], v[148:151], v[164:167]
    s_nop 7
    v_add_f32 v217, v217, v160
    v_min3_f32 v218, v218, v160, v164
    v_add_f32 v217, v217, v164
    v_rcp_f32 v160, v160
    v_rcp_f32 v164, v164
    v_mul_f32 v64, v64, v160
    v_mul_f32 v68, v68, v160
    v_mul_f32 v65, v65, v160
    v_mul_f32 v69, v69, v160
    v_mul_f32 v66, v66, v160
    v_mul_f32 v70, v70, v160
    v_mul_f32 v67, v67, v160
    v_mul_f32 v71, v71, v160
    v_cvt_pk_bf16_f32 v180, v64, v65
    v_cvt_pk_bf16_f32 v181, v66, v67
    v_cvt_pk_bf16_f32 v182, v68, v69
    v_cvt_pk_bf16_f32 v183, v70, v71
    s_nop 1
    v_permlane16_swap_b32 v180, v182
    v_permlane16_swap_b32 v181, v183
    buffer_store_dwordx4 v[180:183], v216, s[8:11], s90 offen sc0 sc1
    v_mul_f32 v72, v72, v160
    v_mul_f32 v76, v76, v160
    v_mul_f32 v73, v73, v160
    v_mul_f32 v77, v77, v160
    v_mul_f32 v74, v74, v160
    v_mul_f32 v78, v78, v160
    v_mul_f32 v75, v75, v160
    v_mul_f32 v79, v79, v160
    v_cvt_pk_bf16_f32 v184, v72, v73
    v_cvt_pk_bf16_f32 v185, v74, v75
    v_cvt_pk_bf16_f32 v186, v76, v77
    v_cvt_pk_bf16_f32 v187, v78, v79
    s_nop 1
    v_permlane16_swap_b32 v184, v186
    v_permlane16_swap_b32 v185, v187
    buffer_store_dwordx4 v[184:187], v216, s[8:11], s90 offen offset:64 sc0 sc1
    v_mul_f32 v80, v80, v160
    v_mul_f32 v84, v84, v160
    v_mul_f32 v81, v81, v160
    v_mul_f32 v85, v85, v160
    v_mul_f32 v82, v82, v160
    v_mul_f32 v86, v86, v160
    v_mul_f32 v83, v83, v160
    v_mul_f32 v87, v87, v160
    v_cvt_pk_bf16_f32 v188, v80, v81
    v_cvt_pk_bf16_f32 v189, v82, v83
    v_cvt_pk_bf16_f32 v190, v84, v85
    v_cvt_pk_bf16_f32 v191, v86, v87
    s_nop 1
    v_permlane16_swap_b32 v188, v190
    v_permlane16_swap_b32 v189, v191
    buffer_store_dwordx4 v[188:191], v216, s[8:11], s90 offen offset:128 sc0 sc1
    v_mul_f32 v88, v88, v160
    v_mul_f32 v92, v92, v160
    v_mul_f32 v89, v89, v160
    v_mul_f32 v93, v93, v160
    v_mul_f32 v90, v90, v160
    v_mul_f32 v94, v94, v160
    v_mul_f32 v91, v91, v160
    v_mul_f32 v95, v95, v160
    v_cvt_pk_bf16_f32 v192, v88, v89
    v_cvt_pk_bf16_f32 v193, v90, v91
    v_cvt_pk_bf16_f32 v194, v92, v93
    v_cvt_pk_bf16_f32 v195, v94, v95
    s_nop 1
    v_permlane16_swap_b32 v192, v194
    v_permlane16_swap_b32 v193, v195
    buffer_store_dwordx4 v[192:195], v216, s[8:11], s90 offen offset:192 sc0 sc1
    s_add_u32 s90, s90, 0x1000
    v_mul_f32 v96, v96, v164
    v_mul_f32 v100, v100, v164
    v_mul_f32 v97, v97, v164
    v_mul_f32 v101, v101, v164
    v_mul_f32 v98, v98, v164
    v_mul_f32 v102, v102, v164
    v_mul_f32 v99, v99, v164
    v_mul_f32 v103, v103, v164
    v_cvt_pk_bf16_f32 v196, v96, v97
    v_cvt_pk_bf16_f32 v197, v98, v99
    v_cvt_pk_bf16_f32 v198, v100, v101
    v_cvt_pk_bf16_f32 v199, v102, v103
    s_nop 1
    v_permlane16_swap_b32 v196, v198
    v_permlane16_swap_b32 v197, v199
    buffer_store_dwordx4 v[196:199], v216, s[8:11], s90 offen sc0 sc1
    v_mul_f32 v104, v104, v164
    v_mul_f32 v108, v108, v164
    v_mul_f32 v105, v105, v164
    v_mul_f32 v109, v109, v164
    v_mul_f32 v106, v106, v164
    v_mul_f32 v110, v110, v164
    v_mul_f32 v107, v107, v164
    v_mul_f32 v111, v111, v164
    v_cvt_pk_bf16_f32 v200, v104, v105
    v_cvt_pk_bf16_f32 v201, v106, v107
    v_cvt_pk_bf16_f32 v202, v108, v109
    v_cvt_pk_bf16_f32 v203, v110, v111
    s_nop 1
    v_permlane16_swap_b32 v200, v202
    v_permlane16_swap_b32 v201, v203
    buffer_store_dwordx4 v[200:203], v216, s[8:11], s90 offen offset:64 sc0 sc1
    v_mul_f32 v112, v112, v164
    v_mul_f32 v116, v116, v164
    v_mul_f32 v113, v113, v164
    v_mul_f32 v117, v117, v164
    v_mul_f32 v114, v114, v164
    v_mul_f32 v118, v118, v164
    v_mul_f32 v115, v115, v164
    v_mul_f32 v119, v119, v164
    v_cvt_pk_bf16_f32 v204, v112, v113
    v_cvt_pk_bf16_f32 v205, v114, v115
    v_cvt_pk_bf16_f32 v206, v116, v117
    v_cvt_pk_bf16_f32 v207, v118, v119
    s_nop 1
    v_permlane16_swap_b32 v204, v206
    v_permlane16_swap_b32 v205, v207
    buffer_store_dwordx4 v[204:207], v216, s[8:11], s90 offen offset:128 sc0 sc1
    v_mul_f32 v120, v120, v164
    v_mul_f32 v124, v124, v164
    v_mul_f32 v121, v121, v164
    v_mul_f32 v125, v125, v164
    v_mul_f32 v122, v122, v164
    v_mul_f32 v126, v126, v164
    v_mul_f32 v123, v123, v164
    v_mul_f32 v127, v127, v164
    v_cvt_pk_bf16_f32 v208, v120, v121
    v_cvt_pk_bf16_f32 v209, v122, v123
    v_cvt_pk_bf16_f32 v210, v124, v125
    v_cvt_pk_bf16_f32 v211, v126, v127
    s_nop 1
    v_permlane16_swap_b32 v208, v210
    v_permlane16_swap_b32 v209, v211
    buffer_store_dwordx4 v[208:211], v216, s[8:11], s90 offen offset:192 sc0 sc1
    s_mov_b32 s86, 0x2b800000
    s_mov_b32 s87, 0x53800000
    v_cmp_ge_f32 s[88:89], s87, v217
    v_cmp_le_f32 s[92:93], s86, v218
    s_nop 4
    s_and_b64 s[88:89], s[88:89], s[92:93]
    s_cmp_eq_u64 s[88:89], -1
    s_cbranch_scc0 L_slow
L_fin:
    s_lshl_b32 s84, s39, 12
    s_lshl_b32 s85, s28, 12
    s_add_u32 s84, s84, s85
    s_add_u32 s84, s84, 0x80
    v_lshlrev_b32 v212, 12, v175
    v_add_u32 v212, s84, v212
    v_mov_b32 v213, s26
    buffer_store_dword v213, v212, s[60:63], 0 offen sc1
    s_endpgm
L_spin_first:
    s_mov_b32 s37, 0
L_spin_first_loop:
    s_add_u32 s55, s55, 1
    buffer_load_dwordx2 v[234:235], v237, s[60:63], 0 offen sc1
    s_waitcnt vmcnt(0)
    v_readfirstlane_b32 s35, v234
    v_readfirstlane_b32 s36, v235
    s_nop 3
    s_sub_u32 s35, s35, s33
    s_sub_u32 s36, s36, s33
    s_max_u32 s35, s35, s36
    s_cmp_lt_u32 s35, 32
    s_cbranch_scc1 L_back_first
    s_add_u32 s37, s37, 1
    s_cmp_lt_u32 s37, 0x40000
    s_cbranch_scc1 L_spin_first_loop
    s_branch L_back_first
L_spin_main:
    s_mov_b32 s37, 0
L_spin_main_loop:
    s_add_u32 s55, s55, 1
    buffer_load_dwordx2 v[234:235], v237, s[60:63], 0 offen sc1
    s_waitcnt vmcnt(0)
    v_readfirstlane_b32 s35, v234
    v_readfirstlane_b32 s36, v235
    s_nop 3
    s_sub_u32 s35, s35, s33
    s_sub_u32 s36, s36, s33
    s_max_u32 s35, s35, s36
    s_cmp_lt_u32 s35, 32
    s_cbranch_scc1 L_back_main
    s_add_u32 s37, s37, 1
    s_cmp_lt_u32 s37, 0x40000
    s_cbranch_scc1 L_spin_main_loop
    s_branch L_back_main
L_slow:
    s_waitcnt vmcnt(0) lgkmcnt(0)
    v_mov_b32 v0, 0
    v_mov_b32 v1, 0
    v_mov_b32 v2, 0
    v_mov_b32 v3, 0
    v_mov_b32 v4, 0
    v_mov_b32 v5, 0
    v_mov_b32 v6, 0
    v_mov_b32 v7, 0
    v_mov_b32 v8, 0
    v_mov_b32 v9, 0
    v_mov_b32 v10, 0
    v_mov_b32 v11, 0
    v_mov_b32 v12, 0
    v_mov_b32 v13, 0
    v_mov_b32 v14, 0
    v_mov_b32 v15, 0
    v_mov_b32 v16, 0
    v_mov_b32 v17, 0
    v_mov_b32 v18, 0
    v_mov_b32 v19, 0
    v_mov_b32 v20, 0
    v_mov_b32 v21, 0
    v_mov_b32 v22, 0
    v_mov_b32 v23, 0
    v_mov_b32 v24, 0
    v_mov_b32 v25, 0
    v_mov_b32 v26, 0
    v_mov_b32 v27, 0
    v_mov_b32 v28, 0
    v_mov_b32 v29, 0
    v_mov_b32 v30, 0
    v_mov_b32 v31, 0
    v_mov_b32 v32, 0
    v_mov_b32 v33, 0
    v_mov_b32 v34, 0
    v_mov_b32 v35, 0
    v_mov_b32 v36, 0
    v_mov_b32 v37, 0
    v_mov_b32 v38, 0
    v_mov_b32 v39, 0
    v_mov_b32 v40, 0
    v_mov_b32 v41, 0
    v_mov_b32 v42, 0
    v_mov_b32 v43, 0
    v_mov_b32 v44, 0
    v_mov_b32 v45, 0
    v_mov_b32 v46, 0
    v_mov_b32 v47, 0
    v_mov_b32 v48, 0
    v_mov_b32 v49, 0
    v_mov_b32 v50, 0
    v_mov_b32 v51, 0
    v_mov_b32 v52, 0
    v_mov_b32 v53, 0
    v_mov_b32 v54, 0
    v_mov_b32 v55, 0
    v_mov_b32 v56, 0
    v_mov_b32 v57, 0
    v_mov_b32 v58, 0
    v_mov_b32 v59, 0
    v_mov_b32 v60, 0
    v_mov_b32 v61, 0
    v_mov_b32 v62, 0
    v_mov_b32 v63, 0
    v_mov_b32 v64, 0
    v_mov_b32 v65, 0
    v_mov_b32 v66, 0
    v_mov_b32 v67, 0
    v_mov_b32 v68, 0
    v_mov_b32 v69, 0
    v_mov_b32 v70, 0
    v_mov_b32 v71, 0
    v_mov_b32 v72, 0
    v_mov_b32 v73, 0
    v_mov_b32 v74, 0
    v_mov_b32 v75, 0
    v_mov_b32 v76, 0
    v_mov_b32 v77, 0
    v_mov_b32 v78, 0
    v_mov_b32 v79, 0
    v_mov_b32 v80, 0
    v_mov_b32 v81, 0
    v_mov_b32 v82, 0
    v_mov_b32 v83, 0
    v_mov_b32 v84, 0
    v_mov_b32 v85, 0
    v_mov_b32 v86, 0
    v_mov_b32 v87, 0
    v_mov_b32 v88, 0
    v_mov_b32 v89, 0
    v_mov_b32 v90, 0
    v_mov_b32 v91, 0
    v_mov_b32 v92, 0
    v_mov_b32 v93, 0
    v_mov_b32 v94, 0
    v_mov_b32 v95, 0
    v_mov_b32 v96, 0
    v_mov_b32 v97, 0
    v_mov_b32 v98, 0
    v_mov_b32 v99, 0
    v_mov_b32 v100, 0
    v_mov_b32 v101, 0
    v_mov_b32 v102, 0
    v_mov_b32 v103, 0
    v_mov_b32 v104, 0
    v_mov_b32 v105, 0
    v_mov_b32 v106, 0
    v_mov_b32 v107, 0
    v_mov_b32 v108, 0
    v_mov_b32 v109, 0
    v_mov_b32 v110, 0
    v_mov_b32 v111, 0
    v_mov_b32 v112, 0
    v_mov_b32 v113, 0
    v_mov_b32 v114, 0
    v_mov_b32 v115, 0
    v_mov_b32 v116, 0
    v_mov_b32 v117, 0
    v_mov_b32 v118, 0
    v_mov_b32 v119, 0
    v_mov_b32 v120, 0
    v_mov_b32 v121, 0
    v_mov_b32 v122, 0
    v_mov_b32 v123, 0
    v_mov_b32 v124, 0
    v_mov_b32 v125, 0
    v_mov_b32 v126, 0
    v_mov_b32 v127, 0
    v_mov_b32 v152, 0
    v_mov_b32 v240, 0xff7fffff
    v_mov_b32 v156, 0
    v_mov_b32 v241, 0xff7fffff
    v_mov_b32 v160, 0
    v_mov_b32 v242, 0xff7fffff
    v_mov_b32 v164, 0
    v_mov_b32 v243, 0xff7fffff
    s_mov_b32 s88, 0
L_slow_loop:
    buffer_load_dwordx4 a[64:67], v176, s[20:23], s88 offen sc1
    buffer_load_dwordx4 a[68:71], v176, s[20:23], s88 offen offset:1024 sc1
    buffer_load_dwordx4 a[72:75], v176, s[20:23], s88 offen offset:2048 sc1
    buffer_load_dwordx4 a[76:79], v176, s[20:23], s88 offen offset:3072 sc1
    buffer_load_dwordx4 a[80:83], v177, s[20:23], s88 offen sc1
    buffer_load_dwordx4 a[84:87], v177, s[20:23], s88 offen offset:1024 sc1
    buffer_load_dwordx4 a[88:91], v177, s[20:23], s88 offen offset:2048 sc1
    buffer_load_dwordx4 a[92:95], v177, s[20:23], s88 offen offset:3072 sc1
    buffer_load_dwordx4 a[128:131], v178, s[20:23], s88 offen sc1
    buffer_load_dwordx4 a[132:135], v178, s[20:23], s88 offen offset:1024 sc1
    buffer_load_dwordx4 a[136:139], v178, s[20:23], s88 offen offset:2048 sc1
    buffer_load_dwordx4 a[140:143], v178, s[20:23], s88 offen offset:3072 sc1
    buffer_load_dwordx4 a[144:147], v179, s[20:23], s88 offen sc1
    buffer_load_dwordx4 a[148:151], v179, s[20:23], s88 offen offset:1024 sc1
    buffer_load_dwordx4 a[152:155], v179, s[20:23], s88 offen offset:2048 sc1
    buffer_load_dwordx4 a[156:159], v179, s[20:23], s88 offen offset:3072 sc1
    s_waitcnt vmcnt(0)
    v_mfma_f32_16x16x32_bf16 v[128:131], a[64:67], a[0:3], 0
    v_mfma_f32_16x16x32_bf16 v[128:131], a[68:71], a[4:7], v[128:131]
    v_mfma_f32_16x16x32_bf16 v[128:131], a[72:75], a[8:11], v[128:131]
    v_mfma_f32_16x16x32_bf16 v[128:131], a[76:79], a[12:15], v[128:131]
    v_mfma_f32_16x16x32_bf16 v[132:135], a[80:83], a[0:3], 0
    v_mfma_f32_16x16x32_bf16 v[132:135], a[84:87], a[4:7], v[132:135]
    v_mfma_f32_16x16x32_bf16 v[132:135], a[88:91], a[8:11], v[132:135]
    v_mfma_f32_16x16x32_bf16 v[132:135], a[92:95], a[12:15], v[132:135]
    s_nop 7
    v_max3_f32 v244, v128, v129, v130
    v_max3_f32 v244, v244, v131, v132
    v_max3_f32 v244, v244, v133, v134
    v_max_f32 v244, v244, v135
    v_mov_b32 v214, v244
    v_mov_b32 v215, v244
    s_nop 1
    v_permlane32_swap_b32 v214, v215
    v_max_f32 v244, v214, v215
    v_mov_b32 v214, v244
    v_mov_b32 v215, v244
    s_nop 1
    v_permlane16_swap_b32 v214, v215
    v_max_f32 v244, v214, v215
    v_max_f32 v244, v244, v240
    v_sub_f32 v245, v240, v244
    v_exp_f32 v245, v245
    v_mov_b32 v240, v244
    v_sub_f32 v128, v128, v244
    v_sub_f32 v129, v129, v244
    v_sub_f32 v130, v130, v244
    v_sub_f32 v131, v131, v244
    v_sub_f32 v132, v132, v244
    v_sub_f32 v133, v133, v244
    v_sub_f32 v134, v134, v244
    v_sub_f32 v135, v135, v244
    v_exp_f32 v128, v128
    v_exp_f32 v129, v129
    v_exp_f32 v130, v130
    v_exp_f32 v131, v131
    v_exp_f32 v132, v132
    v_exp_f32 v133, v133
    v_exp_f32 v134, v134
    v_exp_f32 v135, v135
    v_mul_f32 v152, v152, v245
    v_add_f32 v152, v152, v128
    v_add_f32 v152, v152, v129
    v_add_f32 v152, v152, v130
    v_add_f32 v152, v152, v131
    v_add_f32 v152, v152, v132
    v_add_f32 v152, v152, v133
    v_add_f32 v152, v152, v134
    v_add_f32 v152, v152, v135
    v_cvt_pk_bf16_f32 v144, v128, v129
    v_cvt_pk_bf16_f32 v145, v130, v131
    v_cvt_pk_bf16_f32 v146, v132, v133
    v_cvt_pk_bf16_f32 v147, v134, v135
    v_mul_f32 v0, v0, v245
    v_mul_f32 v1, v1, v245
    v_mul_f32 v2, v2, v245
    v_mul_f32 v3, v3, v245
    v_mul_f32 v4, v4, v245
    v_mul_f32 v5, v5, v245
    v_mul_f32 v6, v6, v245
    v_mul_f32 v7, v7, v245
    v_mul_f32 v8, v8, v245
    v_mul_f32 v9, v9, v245
    v_mul_f32 v10, v10, v245
    v_mul_f32 v11, v11, v245
    v_mul_f32 v12, v12, v245
    v_mul_f32 v13, v13, v245
    v_mul_f32 v14, v14, v245
    v_mul_f32 v15, v15, v245
    v_mul_f32 v16, v16, v245
    v_mul_f32 v17, v17, v245
    v_mul_f32 v18, v18, v245
    v_mul_f32 v19, v19, v245
    v_mul_f32 v20, v20, v245
    v_mul_f32 v21, v21, v245
    v_mul_f32 v22, v22, v245
    v_mul_f32 v23, v23, v245
    v_mul_f32 v24, v24, v245
    v_mul_f32 v25, v25, v245
    v_mul_f32 v26, v26, v245
    v_mul_f32 v27, v27, v245
    v_mul_f32 v28, v28, v245
    v_mul_f32 v29, v29, v245
    v_mul_f32 v30, v30, v245
    v_mul_f32 v31, v31, v245
    s_nop 1
    v_mfma_f32_16x16x32_bf16 v[0:3], a[128:131], v[144:147], v[0:3]
    v_mfma_f32_16x16x32_bf16 v[4:7], a[132:135], v[144:147], v[4:7]
    v_mfma_f32_16x16x32_bf16 v[8:11], a[136:139], v[144:147], v[8:11]
    v_mfma_f32_16x16x32_bf16 v[12:15], a[140:143], v[144:147], v[12:15]
    v_mfma_f32_16x16x32_bf16 v[16:19], a[144:147], v[144:147], v[16:19]
    v_mfma_f32_16x16x32_bf16 v[20:23], a[148:151], v[144:147], v[20:23]
    v_mfma_f32_16x16x32_bf16 v[24:27], a[152:155], v[144:147], v[24:27]
    v_mfma_f32_16x16x32_bf16 v[28:31], a[156:159], v[144:147], v[28:31]
    v_mfma_f32_16x16x32_bf16 v[128:131], a[64:67], a[16:19], 0
    v_mfma_f32_16x16x32_bf16 v[128:131], a[68:71], a[20:23], v[128:131]
    v_mfma_f32_16x16x32_bf16 v[128:131], a[72:75], a[24:27], v[128:131]
    v_mfma_f32_16x16x32_bf16 v[128:131], a[76:79], a[28:31], v[128:131]
    v_mfma_f32_16x16x32_bf16 v[132:135], a[80:83], a[16:19], 0
    v_mfma_f32_16x16x32_bf16 v[132:135], a[84:87], a[20:23], v[132:135]
    v_mfma_f32_16x16x32_bf16 v[132:135], a[88:91], a[24:27], v[132:135]
    v_mfma_f32_16x16x32_bf16 v[132:135], a[92:95], a[28:31], v[132:135]
    s_nop 7
    v_max3_f32 v244, v128, v129, v130
    v_max3_f32 v244, v244, v131, v132
    v_max3_f32 v244, v244, v133, v134
    v_max_f32 v244, v244, v135
    v_mov_b32 v214, v244
    v_mov_b32 v215, v244
    s_nop 1
    v_permlane32_swap_b32 v214, v215
    v_max_f32 v244, v214, v215
    v_mov_b32 v214, v244
    v_mov_b32 v215, v244
    s_nop 1
    v_permlane16_swap_b32 v214, v215
    v_max_f32 v244, v214, v215
    v_max_f32 v244, v244, v241
    v_sub_f32 v245, v241, v244
    v_exp_f32 v245, v245
    v_mov_b32 v241, v244
    v_sub_f32 v128, v128, v244
    v_sub_f32 v129, v129, v244
    v_sub_f32 v130, v130, v244
    v_sub_f32 v131, v131, v244
    v_sub_f32 v132, v132, v244
    v_sub_f32 v133, v133, v244
    v_sub_f32 v134, v134, v244
    v_sub_f32 v135, v135, v244
    v_exp_f32 v128, v128
    v_exp_f32 v129, v129
    v_exp_f32 v130, v130
    v_exp_f32 v131, v131
    v_exp_f32 v132, v132
    v_exp_f32 v133, v133
    v_exp_f32 v134, v134
    v_exp_f32 v135, v135
    v_mul_f32 v156, v156, v245
    v_add_f32 v156, v156, v128
    v_add_f32 v156, v156, v129
    v_add_f32 v156, v156, v130
    v_add_f32 v156, v156, v131
    v_add_f32 v156, v156, v132
    v_add_f32 v156, v156, v133
    v_add_f32 v156, v156, v134
    v_add_f32 v156, v156, v135
    v_cvt_pk_bf16_f32 v144, v128, v129
    v_cvt_pk_bf16_f32 v145, v130, v131
    v_cvt_pk_bf16_f32 v146, v132, v133
    v_cvt_pk_bf16_f32 v147, v134, v135
    v_mul_f32 v32, v32, v245
    v_mul_f32 v33, v33, v245
    v_mul_f32 v34, v34, v245
    v_mul_f32 v35, v35, v245
    v_mul_f32 v36, v36, v245
    v_mul_f32 v37, v37, v245
    v_mul_f32 v38, v38, v245
    v_mul_f32 v39, v39, v245
    v_mul_f32 v40, v40, v245
    v_mul_f32 v41, v41, v245
    v_mul_f32 v42, v42, v245
    v_mul_f32 v43, v43, v245
    v_mul_f32 v44, v44, v245
    v_mul_f32 v45, v45, v245
    v_mul_f32 v46, v46, v245
    v_mul_f32 v47, v47, v245
    v_mul_f32 v48, v48, v245
    v_mul_f32 v49, v49, v245
    v_mul_f32 v50, v50, v245
    v_mul_f32 v51, v51, v245
    v_mul_f32 v52, v52, v245
    v_mul_f32 v53, v53, v245
    v_mul_f32 v54, v54, v245
    v_mul_f32 v55, v55, v245
    v_mul_f32 v56, v56, v245
    v_mul_f32 v57, v57, v245
    v_mul_f32 v58, v58, v245
    v_mul_f32 v59, v59, v245
    v_mul_f32 v60, v60, v245
    v_mul_f32 v61, v61, v245
    v_mul_f32 v62, v62, v245
    v_mul_f32 v63, v63, v245
    s_nop 1
    v_mfma_f32_16x16x32_bf16 v[32:35], a[128:131], v[144:147], v[32:35]
    v_mfma_f32_16x16x32_bf16 v[36:39], a[132:135], v[144:147], v[36:39]
    v_mfma_f32_16x16x32_bf16 v[40:43], a[136:139], v[144:147], v[40:43]
    v_mfma_f32_16x16x32_bf16 v[44:47], a[140:143], v[144:147], v[44:47]
    v_mfma_f32_16x16x32_bf16 v[48:51], a[144:147], v[144:147], v[48:51]
    v_mfma_f32_16x16x32_bf16 v[52:55], a[148:151], v[144:147], v[52:55]
    v_mfma_f32_16x16x32_bf16 v[56:59], a[152:155], v[144:147], v[56:59]
    v_mfma_f32_16x16x32_bf16 v[60:63], a[156:159], v[144:147], v[60:63]
    v_mfma_f32_16x16x32_bf16 v[128:131], a[64:67], a[32:35], 0
    v_mfma_f32_16x16x32_bf16 v[128:131], a[68:71], a[36:39], v[128:131]
    v_mfma_f32_16x16x32_bf16 v[128:131], a[72:75], a[40:43], v[128:131]
    v_mfma_f32_16x16x32_bf16 v[128:131], a[76:79], a[44:47], v[128:131]
    v_mfma_f32_16x16x32_bf16 v[132:135], a[80:83], a[32:35], 0
    v_mfma_f32_16x16x32_bf16 v[132:135], a[84:87], a[36:39], v[132:135]
    v_mfma_f32_16x16x32_bf16 v[132:135], a[88:91], a[40:43], v[132:135]
    v_mfma_f32_16x16x32_bf16 v[132:135], a[92:95], a[44:47], v[132:135]
    s_nop 7
    v_max3_f32 v244, v128, v129, v130
    v_max3_f32 v244, v244, v131, v132
    v_max3_f32 v244, v244, v133, v134
    v_max_f32 v244, v244, v135
    v_mov_b32 v214, v244
    v_mov_b32 v215, v244
    s_nop 1
    v_permlane32_swap_b32 v214, v215
    v_max_f32 v244, v214, v215
    v_mov_b32 v214, v244
    v_mov_b32 v215, v244
    s_nop 1
    v_permlane16_swap_b32 v214, v215
    v_max_f32 v244, v214, v215
    v_max_f32 v244, v244, v242
    v_sub_f32 v245, v242, v244
    v_exp_f32 v245, v245
    v_mov_b32 v242, v244
    v_sub_f32 v128, v128, v244
    v_sub_f32 v129, v129, v244
    v_sub_f32 v130, v130, v244
    v_sub_f32 v131, v131, v244
    v_sub_f32 v132, v132, v244
    v_sub_f32 v133, v133, v244
    v_sub_f32 v134, v134, v244
    v_sub_f32 v135, v135, v244
    v_exp_f32 v128, v128
    v_exp_f32 v129, v129
    v_exp_f32 v130, v130
    v_exp_f32 v131, v131
    v_exp_f32 v132, v132
    v_exp_f32 v133, v133
    v_exp_f32 v134, v134
    v_exp_f32 v135, v135
    v_mul_f32 v160, v160, v245
    v_add_f32 v160, v160, v128
    v_add_f32 v160, v160, v129
    v_add_f32 v160, v160, v130
    v_add_f32 v160, v160, v131
    v_add_f32 v160, v160, v132
    v_add_f32 v160, v160, v133
    v_add_f32 v160, v160, v134
    v_add_f32 v160, v160, v135
    v_cvt_pk_bf16_f32 v144, v128, v129
    v_cvt_pk_bf16_f32 v145, v130, v131
    v_cvt_pk_bf16_f32 v146, v132, v133
    v_cvt_pk_bf16_f32 v147, v134, v135
    v_mul_f32 v64, v64, v245
    v_mul_f32 v65, v65, v245
    v_mul_f32 v66, v66, v245
    v_mul_f32 v67, v67, v245
    v_mul_f32 v68, v68, v245
    v_mul_f32 v69, v69, v245
    v_mul_f32 v70, v70, v245
    v_mul_f32 v71, v71, v245
    v_mul_f32 v72, v72, v245
    v_mul_f32 v73, v73, v245
    v_mul_f32 v74, v74, v245
    v_mul_f32 v75, v75, v245
    v_mul_f32 v76, v76, v245
    v_mul_f32 v77, v77, v245
    v_mul_f32 v78, v78, v245
    v_mul_f32 v79, v79, v245
    v_mul_f32 v80, v80, v245
    v_mul_f32 v81, v81, v245
    v_mul_f32 v82, v82, v245
    v_mul_f32 v83, v83, v245
    v_mul_f32 v84, v84, v245
    v_mul_f32 v85, v85, v245
    v_mul_f32 v86, v86, v245
    v_mul_f32 v87, v87, v245
    v_mul_f32 v88, v88, v245
    v_mul_f32 v89, v89, v245
    v_mul_f32 v90, v90, v245
    v_mul_f32 v91, v91, v245
    v_mul_f32 v92, v92, v245
    v_mul_f32 v93, v93, v245
    v_mul_f32 v94, v94, v245
    v_mul_f32 v95, v95, v245
    s_nop 1
    v_mfma_f32_16x16x32_bf16 v[64:67], a[128:131], v[144:147], v[64:67]
    v_mfma_f32_16x16x32_bf16 v[68:71], a[132:135], v[144:147], v[68:71]
    v_mfma_f32_16x16x32_bf16 v[72:75], a[136:139], v[144:147], v[72:75]
    v_mfma_f32_16x16x32_bf16 v[76:79], a[140:143], v[144:147], v[76:79]
    v_mfma_f32_16x16x32_bf16 v[80:83], a[144:147], v[144:147], v[80:83]
    v_mfma_f32_16x16x32_bf16 v[84:87], a[148:151], v[144:147], v[84:87]
    v_mfma_f32_16x16x32_bf16 v[88:91], a[152:155], v[144:147], v[88:91]
    v_mfma_f32_16x16x32_bf16 v[92:95], a[156:159], v[144:147], v[92:95]
    v_mfma_f32_16x16x32_bf16 v[128:131], a[64:67], a[48:51], 0
    v_mfma_f32_16x16x32_bf16 v[128:131], a[68:71], a[52:55], v[128:131]
    v_mfma_f32_16x16x32_bf16 v[128:131], a[72:75], a[56:59], v[128:131]
    v_mfma_f32_16x16x32_bf16 v[128:131], a[76:79], a[60:63], v[128:131]
    v_mfma_f32_16x16x32_bf16 v[132:135], a[80:83], a[48:51], 0
    v_mfma_f32_16x16x32_bf16 v[132:135], a[84:87], a[52:55], v[132:135]
    v_mfma_f32_16x16x32_bf16 v[132:135], a[88:91], a[56:59], v[132:135]
    v_mfma_f32_16x16x32_bf16 v[132:135], a[92:95], a[60:63], v[132:135]
    s_nop 7
    v_max3_f32 v244, v128, v129, v130
    v_max3_f32 v244, v244, v131, v132
    v_max3_f32 v244, v244, v133, v134
    v_max_f32 v244, v244, v135
    v_mov_b32 v214, v244
    v_mov_b32 v215, v244
    s_nop 1
    v_permlane32_swap_b32 v214, v215
    v_max_f32 v244, v214, v215
    v_mov_b32 v214, v244
    v_mov_b32 v215, v244
    s_nop 1
    v_permlane16_swap_b32 v214, v215
    v_max_f32 v244, v214, v215
    v_max_f32 v244, v244, v243
    v_sub_f32 v245, v243, v244
    v_exp_f32 v245, v245
    v_mov_b32 v243, v244
    v_sub_f32 v128, v128, v244
    v_sub_f32 v129, v129, v244
    v_sub_f32 v130, v130, v244
    v_sub_f32 v131, v131, v244
    v_sub_f32 v132, v132, v244
    v_sub_f32 v133, v133, v244
    v_sub_f32 v134, v134, v244
    v_sub_f32 v135, v135, v244
    v_exp_f32 v128, v128
    v_exp_f32 v129, v129
    v_exp_f32 v130, v130
    v_exp_f32 v131, v131
    v_exp_f32 v132, v132
    v_exp_f32 v133, v133
    v_exp_f32 v134, v134
    v_exp_f32 v135, v135
    v_mul_f32 v164, v164, v245
    v_add_f32 v164, v164, v128
    v_add_f32 v164, v164, v129
    v_add_f32 v164, v164, v130
    v_add_f32 v164, v164, v131
    v_add_f32 v164, v164, v132
    v_add_f32 v164, v164, v133
    v_add_f32 v164, v164, v134
    v_add_f32 v164, v164, v135
    v_cvt_pk_bf16_f32 v144, v128, v129
    v_cvt_pk_bf16_f32 v145, v130, v131
    v_cvt_pk_bf16_f32 v146, v132, v133
    v_cvt_pk_bf16_f32 v147, v134, v135
    v_mul_f32 v96, v96, v245
    v_mul_f32 v97, v97, v245
    v_mul_f32 v98, v98, v245
    v_mul_f32 v99, v99, v245
    v_mul_f32 v100, v100, v245
    v_mul_f32 v101, v101, v245
    v_mul_f32 v102, v102, v245
    v_mul_f32 v103, v103, v245
    v_mul_f32 v104, v104, v245
    v_mul_f32 v105, v105, v245
    v_mul_f32 v106, v106, v245
    v_mul_f32 v107, v107, v245
    v_mul_f32 v108, v108, v245
    v_mul_f32 v109, v109, v245
    v_mul_f32 v110, v110, v245
    v_mul_f32 v111, v111, v245
    v_mul_f32 v112, v112, v245
    v_mul_f32 v113, v113, v245
    v_mul_f32 v114, v114, v245
    v_mul_f32 v115, v115, v245
    v_mul_f32 v116, v116, v245
    v_mul_f32 v117, v117, v245
    v_mul_f32 v118, v118, v245
    v_mul_f32 v119, v119, v245
    v_mul_f32 v120, v120, v245
    v_mul_f32 v121, v121, v245
    v_mul_f32 v122, v122, v245
    v_mul_f32 v123, v123, v245
    v_mul_f32 v124, v124, v245
    v_mul_f32 v125, v125, v245
    v_mul_f32 v126, v126, v245
    v_mul_f32 v127, v127, v245
    s_nop 1
    v_mfma_f32_16x16x32_bf16 v[96:99], a[128:131], v[144:147], v[96:99]
    v_mfma_f32_16x16x32_bf16 v[100:103], a[132:135], v[144:147], v[100:103]
    v_mfma_f32_16x16x32_bf16 v[104:107], a[136:139], v[144:147], v[104:107]
    v_mfma_f32_16x16x32_bf16 v[108:111], a[140:143], v[144:147], v[108:111]
    v_mfma_f32_16x16x32_bf16 v[112:115], a[144:147], v[144:147], v[112:115]
    v_mfma_f32_16x16x32_bf16 v[116:119], a[148:151], v[144:147], v[116:119]
    v_mfma_f32_16x16x32_bf16 v[120:123], a[152:155], v[144:147], v[120:123]
    v_mfma_f32_16x16x32_bf16 v[124:127], a[156:159], v[144:147], v[124:127]
    s_add_u32 s88, s88, 0x4000
    s_cmp_lt_u32 s88, 0x100000
    s_nop 7
    s_cbranch_scc1 L_slow_loop
    v_mov_b32 v214, v152
    v_mov_b32 v215, v152
    s_nop 1
    v_permlane32_swap_b32 v214, v215
    v_add_f32 v152, v214, v215
    v_mov_b32 v214, v152
    v_mov_b32 v215, v152
    s_nop 1
    v_permlane16_swap_b32 v214, v215
    v_add_f32 v152, v214, v215
    v_mov_b32 v214, v156
    v_mov_b32 v215, v156
    s_nop 1
    v_permlane32_swap_b32 v214, v215
    v_add_f32 v156, v214, v215
    v_mov_b32 v214, v156
    v_mov_b32 v215, v156
    s_nop 1
    v_permlane16_swap_b32 v214, v215
    v_add_f32 v156, v214, v215
    v_mov_b32 v214, v160
    v_mov_b32 v215, v160
    s_nop 1
    v_permlane32_swap_b32 v214, v215
    v_add_f32 v160, v214, v215
    v_mov_b32 v214, v160
    v_mov_b32 v215, v160
    s_nop 1
    v_permlane16_swap_b32 v214, v215
    v_add_f32 v160, v214, v215
    v_mov_b32 v214, v164
    v_mov_b32 v215, v164
    s_nop 1
    v_permlane32_swap_b32 v214, v215
    v_add_f32 v164, v214, v215
    v_mov_b32 v214, v164
    v_mov_b32 v215, v164
    s_nop 1
    v_permlane16_swap_b32 v214, v215
    v_add_f32 v164, v214, v215
    s_mov_b32 s8, s56
    s_and_b32 s9, s57, 0xffff
    s_mov_b32 s10, 0x10000
    s_mov_b32 s11, 0x20000
    v_and_b32 v216, 15, v175
    v_lshlrev_b32 v216, 8, v216
    v_bfe_u32 v219, v175, 4, 1
    v_lshlrev_b32 v219, 5, v219
    v_add_u32 v216, v216, v219
    v_lshrrev_b32 v219, 5, v175
    v_lshlrev_b32 v219, 4, v219
    v_add_u32 v216, v216, v219
    s_lshl_b32 s90, s28, 14
    v_rcp_f32 v152, v152
    v_rcp_f32 v156, v156
    v_rcp_f32 v160, v160
    v_rcp_f32 v164, v164
    v_mul_f32 v0, v0, v152
    v_mul_f32 v4, v4, v152
    v_mul_f32 v1, v1, v152
    v_mul_f32 v5, v5, v152
    v_mul_f32 v2, v2, v152
    v_mul_f32 v6, v6, v152
    v_mul_f32 v3, v3, v152
    v_mul_f32 v7, v7, v152
    v_cvt_pk_bf16_f32 v180, v0, v1
    v_cvt_pk_bf16_f32 v181, v2, v3
    v_cvt_pk_bf16_f32 v182, v4, v5
    v_cvt_pk_bf16_f32 v183, v6, v7
    s_nop 1
    v_permlane16_swap_b32 v180, v182
    v_permlane16_swap_b32 v181, v183
    buffer_store_dwordx4 v[180:183], v216, s[8:11], s90 offen sc0 sc1
    v_mul_f32 v8, v8, v152
    v_mul_f32 v12, v12, v152
    v_mul_f32 v9, v9, v152
    v_mul_f32 v13, v13, v152
    v_mul_f32 v10, v10, v152
    v_mul_f32 v14, v14, v152
    v_mul_f32 v11, v11, v152
    v_mul_f32 v15, v15, v152
    v_cvt_pk_bf16_f32 v184, v8, v9
    v_cvt_pk_bf16_f32 v185, v10, v11
    v_cvt_pk_bf16_f32 v186, v12, v13
    v_cvt_pk_bf16_f32 v187, v14, v15
    s_nop 1
    v_permlane16_swap_b32 v184, v186
    v_permlane16_swap_b32 v185, v187
    buffer_store_dwordx4 v[184:187], v216, s[8:11], s90 offen offset:64 sc0 sc1
    v_mul_f32 v16, v16, v152
    v_mul_f32 v20, v20, v152
    v_mul_f32 v17, v17, v152
    v_mul_f32 v21, v21, v152
    v_mul_f32 v18, v18, v152
    v_mul_f32 v22, v22, v152
    v_mul_f32 v19, v19, v152
    v_mul_f32 v23, v23, v152
    v_cvt_pk_bf16_f32 v188, v16, v17
    v_cvt_pk_bf16_f32 v189, v18, v19
    v_cvt_pk_bf16_f32 v190, v20, v21
    v_cvt_pk_bf16_f32 v191, v22, v23
    s_nop 1
    v_permlane16_swap_b32 v188, v190
    v_permlane16_swap_b32 v189, v191
    buffer_store_dwordx4 v[188:191], v216, s[8:11], s90 offen offset:128 sc0 sc1
    v_mul_f32 v24, v24, v152
    v_mul_f32 v28, v28, v152
    v_mul_f32 v25, v25, v152
    v_mul_f32 v29, v29, v152
    v_mul_f32 v26, v26, v152
    v_mul_f32 v30, v30, v152
    v_mul_f32 v27, v27, v152
    v_mul_f32 v31, v31, v152
    v_cvt_pk_bf16_f32 v192, v24, v25
    v_cvt_pk_bf16_f32 v193, v26, v27
    v_cvt_pk_bf16_f32 v194, v28, v29
    v_cvt_pk_bf16_f32 v195, v30, v31
    s_nop 1
    v_permlane16_swap_b32 v192, v194
    v_permlane16_swap_b32 v193, v195
    buffer_store_dwordx4 v[192:195], v216, s[8:11], s90 offen offset:192 sc0 sc1
    s_add_u32 s90, s90, 0x1000
    v_mul_f32 v32, v32, v156
    v_mul_f32 v36, v36, v156
    v_mul_f32 v33, v33, v156
    v_mul_f32 v37, v37, v156
    v_mul_f32 v34, v34, v156
    v_mul_f32 v38, v38, v156
    v_mul_f32 v35, v35, v156
    v_mul_f32 v39, v39, v156
    v_cvt_pk_bf16_f32 v196, v32, v33
    v_cvt_pk_bf16_f32 v197, v34, v35
    v_cvt_pk_bf16_f32 v198, v36, v37
    v_cvt_pk_bf16_f32 v199, v38, v39
    s_nop 1
    v_permlane16_swap_b32 v196, v198
    v_permlane16_swap_b32 v197, v199
    buffer_store_dwordx4 v[196:199], v216, s[8:11], s90 offen sc0 sc1
    v_mul_f32 v40, v40, v156
    v_mul_f32 v44, v44, v156
    v_mul_f32 v41, v41, v156
    v_mul_f32 v45, v45, v156
    v_mul_f32 v42, v42, v156
    v_mul_f32 v46, v46, v156
    v_mul_f32 v43, v43, v156
    v_mul_f32 v47, v47, v156
    v_cvt_pk_bf16_f32 v200, v40, v41
    v_cvt_pk_bf16_f32 v201, v42, v43
    v_cvt_pk_bf16_f32 v202, v44, v45
    v_cvt_pk_bf16_f32 v203, v46, v47
    s_nop 1
    v_permlane16_swap_b32 v200, v202
    v_permlane16_swap_b32 v201, v203
    buffer_store_dwordx4 v[200:203], v216, s[8:11], s90 offen offset:64 sc0 sc1
    v_mul_f32 v48, v48, v156
    v_mul_f32 v52, v52, v156
    v_mul_f32 v49, v49, v156
    v_mul_f32 v53, v53, v156
    v_mul_f32 v50, v50, v156
    v_mul_f32 v54, v54, v156
    v_mul_f32 v51, v51, v156
    v_mul_f32 v55, v55, v156
    v_cvt_pk_bf16_f32 v204, v48, v49
    v_cvt_pk_bf16_f32 v205, v50, v51
    v_cvt_pk_bf16_f32 v206, v52, v53
    v_cvt_pk_bf16_f32 v207, v54, v55
    s_nop 1
    v_permlane16_swap_b32 v204, v206
    v_permlane16_swap_b32 v205, v207
    buffer_store_dwordx4 v[204:207], v216, s[8:11], s90 offen offset:128 sc0 sc1
    v_mul_f32 v56, v56, v156
    v_mul_f32 v60, v60, v156
    v_mul_f32 v57, v57, v156
    v_mul_f32 v61, v61, v156
    v_mul_f32 v58, v58, v156
    v_mul_f32 v62, v62, v156
    v_mul_f32 v59, v59, v156
    v_mul_f32 v63, v63, v156
    v_cvt_pk_bf16_f32 v208, v56, v57
    v_cvt_pk_bf16_f32 v209, v58, v59
    v_cvt_pk_bf16_f32 v210, v60, v61
    v_cvt_pk_bf16_f32 v211, v62, v63
    s_nop 1
    v_permlane16_swap_b32 v208, v210
    v_permlane16_swap_b32 v209, v211
    buffer_store_dwordx4 v[208:211], v216, s[8:11], s90 offen offset:192 sc0 sc1
    s_add_u32 s90, s90, 0x1000
    v_mul_f32 v64, v64, v160
    v_mul_f32 v68, v68, v160
    v_mul_f32 v65, v65, v160
    v_mul_f32 v69, v69, v160
    v_mul_f32 v66, v66, v160
    v_mul_f32 v70, v70, v160
    v_mul_f32 v67, v67, v160
    v_mul_f32 v71, v71, v160
    v_cvt_pk_bf16_f32 v180, v64, v65
    v_cvt_pk_bf16_f32 v181, v66, v67
    v_cvt_pk_bf16_f32 v182, v68, v69
    v_cvt_pk_bf16_f32 v183, v70, v71
    s_nop 1
    v_permlane16_swap_b32 v180, v182
    v_permlane16_swap_b32 v181, v183
    buffer_store_dwordx4 v[180:183], v216, s[8:11], s90 offen sc0 sc1
    v_mul_f32 v72, v72, v160
    v_mul_f32 v76, v76, v160
    v_mul_f32 v73, v73, v160
    v_mul_f32 v77, v77, v160
    v_mul_f32 v74, v74, v160
    v_mul_f32 v78, v78, v160
    v_mul_f32 v75, v75, v160
    v_mul_f32 v79, v79, v160
    v_cvt_pk_bf16_f32 v184, v72, v73
    v_cvt_pk_bf16_f32 v185, v74, v75
    v_cvt_pk_bf16_f32 v186, v76, v77
    v_cvt_pk_bf16_f32 v187, v78, v79
    s_nop 1
    v_permlane16_swap_b32 v184, v186
    v_permlane16_swap_b32 v185, v187
    buffer_store_dwordx4 v[184:187], v216, s[8:11], s90 offen offset:64 sc0 sc1
    v_mul_f32 v80, v80, v160
    v_mul_f32 v84, v84, v160
    v_mul_f32 v81, v81, v160
    v_mul_f32 v85, v85, v160
    v_mul_f32 v82, v82, v160
    v_mul_f32 v86, v86, v160
    v_mul_f32 v83, v83, v160
    v_mul_f32 v87, v87, v160
    v_cvt_pk_bf16_f32 v188, v80, v81
    v_cvt_pk_bf16_f32 v189, v82, v83
    v_cvt_pk_bf16_f32 v190, v84, v85
    v_cvt_pk_bf16_f32 v191, v86, v87
    s_nop 1
    v_permlane16_swap_b32 v188, v190
    v_permlane16_swap_b32 v189, v191
    buffer_store_dwordx4 v[188:191], v216, s[8:11], s90 offen offset:128 sc0 sc1
    v_mul_f32 v88, v88, v160
    v_mul_f32 v92, v92, v160
    v_mul_f32 v89, v89, v160
    v_mul_f32 v93, v93, v160
    v_mul_f32 v90, v90, v160
    v_mul_f32 v94, v94, v160
    v_mul_f32 v91, v91, v160
    v_mul_f32 v95, v95, v160
    v_cvt_pk_bf16_f32 v192, v88, v89
    v_cvt_pk_bf16_f32 v193, v90, v91
    v_cvt_pk_bf16_f32 v194, v92, v93
    v_cvt_pk_bf16_f32 v195, v94, v95
    s_nop 1
    v_permlane16_swap_b32 v192, v194
    v_permlane16_swap_b32 v193, v195
    buffer_store_dwordx4 v[192:195], v216, s[8:11], s90 offen offset:192 sc0 sc1
    s_add_u32 s90, s90, 0x1000
    v_mul_f32 v96, v96, v164
    v_mul_f32 v100, v100, v164
    v_mul_f32 v97, v97, v164
    v_mul_f32 v101, v101, v164
    v_mul_f32 v98, v98, v164
    v_mul_f32 v102, v102, v164
    v_mul_f32 v99, v99, v164
    v_mul_f32 v103, v103, v164
    v_cvt_pk_bf16_f32 v196, v96, v97
    v_cvt_pk_bf16_f32 v197, v98, v99
    v_cvt_pk_bf16_f32 v198, v100, v101
    v_cvt_pk_bf16_f32 v199, v102, v103
    s_nop 1
    v_permlane16_swap_b32 v196, v198
    v_permlane16_swap_b32 v197, v199
    buffer_store_dwordx4 v[196:199], v216, s[8:11], s90 offen sc0 sc1
    v_mul_f32 v104, v104, v164
    v_mul_f32 v108, v108, v164
    v_mul_f32 v105, v105, v164
    v_mul_f32 v109, v109, v164
    v_mul_f32 v106, v106, v164
    v_mul_f32 v110, v110, v164
    v_mul_f32 v107, v107, v164
    v_mul_f32 v111, v111, v164
    v_cvt_pk_bf16_f32 v200, v104, v105
    v_cvt_pk_bf16_f32 v201, v106, v107
    v_cvt_pk_bf16_f32 v202, v108, v109
    v_cvt_pk_bf16_f32 v203, v110, v111
    s_nop 1
    v_permlane16_swap_b32 v200, v202
    v_permlane16_swap_b32 v201, v203
    buffer_store_dwordx4 v[200:203], v216, s[8:11], s90 offen offset:64 sc0 sc1
    v_mul_f32 v112, v112, v164
    v_mul_f32 v116, v116, v164
    v_mul_f32 v113, v113, v164
    v_mul_f32 v117, v117, v164
    v_mul_f32 v114, v114, v164
    v_mul_f32 v118, v118, v164
    v_mul_f32 v115, v115, v164
    v_mul_f32 v119, v119, v164
    v_cvt_pk_bf16_f32 v204, v112, v113
    v_cvt_pk_bf16_f32 v205, v114, v115
    v_cvt_pk_bf16_f32 v206, v116, v117
    v_cvt_pk_bf16_f32 v207, v118, v119
    s_nop 1
    v_permlane16_swap_b32 v204, v206
    v_permlane16_swap_b32 v205, v207
    buffer_store_dwordx4 v[204:207], v216, s[8:11], s90 offen offset:128 sc0 sc1
    v_mul_f32 v120, v120, v164
    v_mul_f32 v124, v124, v164
    v_mul_f32 v121, v121, v164
    v_mul_f32 v125, v125, v164
    v_mul_f32 v122, v122, v164
    v_mul_f32 v126, v126, v164
    v_mul_f32 v123, v123, v164
    v_mul_f32 v127, v127, v164
    v_cvt_pk_bf16_f32 v208, v120, v121
    v_cvt_pk_bf16_f32 v209, v122, v123
    v_cvt_pk_bf16_f32 v210, v124, v125
    v_cvt_pk_bf16_f32 v211, v126, v127
    s_nop 1
    v_permlane16_swap_b32 v208, v210
    v_permlane16_swap_b32 v209, v211
    buffer_store_dwordx4 v[208:211], v216, s[8:11], s90 offen offset:192 sc0 sc1
    s_branch L_fin
L_done:
    s_endpgm
.section .rodata,"a"
.p2align 6
.amdhsa_kernel standalone__kv_cache_quant_int4_int2_kv_with_per_channel_or_per_token_scales__prompt_kernel
  .amdhsa_next_free_vgpr 512
  .amdhsa_next_free_sgpr 102
  .amdhsa_accum_offset 256
  .amdhsa_group_segment_fixed_size 0
  .amdhsa_kernarg_size 80
  .amdhsa_user_sgpr_count 2
  .amdhsa_user_sgpr_kernarg_segment_ptr 1
  .amdhsa_system_sgpr_workgroup_id_x 1
  .amdhsa_float_denorm_mode_32 3
.end_amdhsa_kernel
```
